```python
import torch

def _softmax(x, axis=-1):
    return torch.softmax(x, dim=axis)
def _gelu(x):
    return torch.nn.functional.gelu(x, approximate="tanh")
def _silu(x):
    return torch.nn.functional.silu(x)
def _sigmoid(x):
    return torch.sigmoid(x)
def _layernorm(x, axis=-1, eps=1e-5):
    m = x.mean(dim=axis, keepdim=True)
    v = x.var(dim=axis, keepdim=True, unbiased=False)
    return (x - m) / torch.sqrt(v + eps)
def _scatter_add(tgt, idx, src, axis=0):
    return tgt.clone().index_add_(axis, idx, src)
def _segment_sum(src, seg, n):
    out = torch.zeros((n,) + src.shape[1:], dtype=src.dtype)
    return out.index_add_(0, seg, src)
def _pad(x, pw):
    flat = tuple(v for pair in reversed(pw) for v in pair)
    return torch.nn.functional.pad(x, flat)

kernel_name = 'recurrent_scan__mha_block_cached__dense_activation_silu__decode'

def setup_inputs():

    _w = (lambda a: (lambda t: t.to(torch.bfloat16) if t.is_floating_point() else t)(torch.as_tensor(a)))
    def _A_setup():
        B, Sq, D = 1, 1, 448
        H, Sk, Dh = 16, 65536, 256
        return {
            "x": _w((lambda *s: torch.randn(*s, dtype=torch.bfloat16) * 0.4)(B, Sq, D)),
            "k_cache": _w((lambda *s: torch.randn(*s, dtype=torch.bfloat16) * 1.6)(B, H, Sk, Dh)),
            "v_cache": _w((lambda *s: torch.randn(*s, dtype=torch.bfloat16) * 1.6)(B, H, Sk, Dh)),
            "wq": _w((lambda *s: torch.randn(*s, dtype=torch.bfloat16) * 1.6)(D, H * Dh) * (D ** -0.5)),
            "wo": _w((lambda *s: torch.randn(*s, dtype=torch.bfloat16) * 1.6)(H * Dh, D) * ((H * Dh) ** -0.5)),
        }
    _A_in = _A_setup()

    def _B_setup():
        B, S, D, F = 1, 1, 448, 1792
        return {
            "x": _w((lambda *s: torch.randn(*s, dtype=torch.bfloat16) * 0.4)(B, S, D)),
            "w1": _w((lambda *s: torch.randn(*s, dtype=torch.bfloat16) * 1.6)(D, F) * (D ** -0.5)),
            "w2": _w((lambda *s: torch.randn(*s, dtype=torch.bfloat16) * 1.6)(F, D) * (F ** -0.5)),
        }
    _B_in = _B_setup()

    return {
        "A_x": _A_in["x"],
        "A_k_cache": _A_in["k_cache"],
        "A_v_cache": _A_in["v_cache"],
        "A_wq": _A_in["wq"],
        "A_wo": _A_in["wo"],
        "B_x": _B_in["x"],
        "B_w1": _B_in["w1"],
        "B_w2": _B_in["w2"],
    }

def reference(A_x, A_k_cache, A_v_cache, A_wq, A_wo, B_x, B_w1, B_w2):
    def _A_ref(x, k_cache, v_cache, wq, wo):
        B, Sq, D = x.shape
        H, Dh = 16, 256
        q = (lambda x, *d: x.permute(*d))((x @ wq).reshape(B, Sq, H, Dh), 0, 2, 1, 3)
        scores = torch.einsum("bhqd,bhkd->bhqk", q, k_cache) * (Dh ** -0.5)
        p = _softmax(scores, axis=-1)
        o = torch.einsum("bhqk,bhkd->bhqd", p, v_cache)
        return (lambda x, *d: x.permute(*d))(o, 0, 2, 1, 3).reshape(B, Sq, H * Dh) @ wo

    def _B_ref(x, w1, w2):
        h = torch.einsum("bsd,df->bsf", x, w1)
        h = _silu(h)
        out = torch.einsum("bsf,fd->bsd", h, w2)
        return out

    x = A_x
    xn = _layernorm(x, axis=-1)
    s = _A_ref(xn, A_k_cache, A_v_cache, A_wq, A_wo)
    g = _silu(_B_ref(xn, B_w1, B_w2))
    return x + s * g
```

```asm
; @launch grid=(256,1,1) block=(320,1,1) lds=29696
.amdgcn_target "amdgcn-amd-amdhsa--gfx950"
.text
.globl recurrent_scan__mha_block_cached__dense_activation_silu__decode_kernel
.p2align 8
.type recurrent_scan__mha_block_cached__dense_activation_silu__decode_kernel,@function
recurrent_scan__mha_block_cached__dense_activation_silu__decode_kernel:
    s_cmp_ge_u32 s2, 256
    s_cbranch_scc1 L_end
    s_load_dwordx16 s[64:79], s[0:1], 0
    s_load_dwordx4 s[80:83], s[0:1], 64
    s_load_dwordx2 s[84:85], s[0:1], 80
    v_lshrrev_b32 v1, 6, v0
    s_nop 0
    v_readfirstlane_b32 s3, v1
    v_and_b32 v0, 63, v0
    s_lshr_b32 s4, s2, 4
    s_and_b32 s5, s2, 15
    s_cmp_eq_u32 s3, 0
    s_cbranch_scc1 L_helper
    v_cmp_eq_u32 vcc, 0, v0
    v_lshlrev_b32 v0, 4, v0
    v_lshrrev_b32 v2, 9, v0
    v_and_b32 v3, 0x1f0, v0
    v_lshl_or_b32 v2, v2, 15, v3
    s_lshl_b32 s6, s4, 25
    s_lshl_b32 s29, s5, 21
    s_sub_u32 s7, s3, 1
    s_lshl_b32 s24, s7, 12
    s_add_u32 s21, s29, s24
    s_and_b32 s24, s7, 1
    s_mul_i32 s24, s24, 4096
    s_lshr_b32 s21, s7, 1
    s_mul_i32 s21, s21, 1024
    s_add_u32 s21, s21, s24
    s_add_u32 s21, s21, s29
    s_add_u32 s22, s21, 2048
    s_add_u32 s32, s21, 512
    s_add_u32 s33, s21, 2560
    s_waitcnt lgkmcnt(0)
    s_add_u32 s8, s66, s6
    s_addc_u32 s9, s67, 0
    s_mov_b32 s10, 33554432
    s_mov_b32 s11, 0x20000
    s_add_u32 s12, s68, s6
    s_addc_u32 s13, s69, 0
    s_mov_b32 s14, 33554432
    s_mov_b32 s15, 0x20000
    s_barrier
    buffer_load_dwordx4 v[44:47], v2, s[8:11], s21 offen offset:0 nt
    s_add_u32 s28, s21, 65536
    buffer_load_dwordx4 v[48:51], v2, s[8:11], s28 offen offset:0 nt
    s_add_u32 s28, s21, 8192
    buffer_load_dwordx4 v[52:55], v2, s[8:11], s28 offen offset:0 nt
    s_add_u32 s28, s21, 73728
    buffer_load_dwordx4 v[56:59], v2, s[8:11], s28 offen offset:0 nt
    buffer_load_dwordx4 v[60:63], v2, s[12:15], s21 offen offset:0 nt
    s_add_u32 s28, s21, 65536
    buffer_load_dwordx4 v[64:67], v2, s[12:15], s28 offen offset:0 nt
    s_add_u32 s28, s21, 8192
    buffer_load_dwordx4 v[68:71], v2, s[12:15], s28 offen offset:0 nt
    s_add_u32 s28, s21, 73728
    buffer_load_dwordx4 v[72:75], v2, s[12:15], s28 offen offset:0 nt
    s_mov_b32 s26, 1035512379
    s_mov_b32 s27, 0xffff0000
    s_mov_b32 s31, 0
    v_mov_b32 v8, -1
    v_mov_b32 v9, -1
    v_mov_b32 v10, -1
    v_mov_b32 v11, -1
    v_mov_b32 v12, -1
    v_mov_b32 v13, -1
    v_mov_b32 v14, -1
    v_mov_b32 v15, -1
    s_mul_i32 s24, s7, 5120
    v_add_u32 v18, s24, v0
    ds_write_b128 v18, v[8:11] offset:9216
    ds_write_b128 v18, v[8:11] offset:10240
    ds_write_b128 v18, v[8:11] offset:11264
    ds_write_b128 v18, v[8:11] offset:12288
    ds_write_b128 v18, v[8:11] offset:13312
    v_lshrrev_b32 v18, 4, v0
    s_lshl_b32 s24, s7, 6
    v_add_u32 v19, s24, v18
    v_lshlrev_b32 v18, 2, v19
    v_bfe_u32 v20, v19, 0, 1
    v_lshlrev_b32 v20, 3, v20
    v_xor_b32 v19, v19, v20
    v_bfe_u32 v20, v19, 3, 1
    v_lshlrev_b32 v20, 0, v20
    v_xor_b32 v19, v19, v20
    v_bfe_u32 v20, v19, 0, 1
    v_lshlrev_b32 v20, 3, v20
    v_xor_b32 v19, v19, v20
    v_bfe_u32 v20, v19, 4, 1
    v_lshlrev_b32 v20, 6, v20
    v_xor_b32 v19, v19, v20
    v_bfe_u32 v20, v19, 6, 1
    v_lshlrev_b32 v20, 4, v20
    v_xor_b32 v19, v19, v20
    v_bfe_u32 v20, v19, 4, 1
    v_lshlrev_b32 v20, 6, v20
    v_xor_b32 v19, v19, v20
    v_and_b32 v20, 15, v19
    v_lshrrev_b32 v19, 4, v19
    v_lshl_or_b32 v19, v19, 5, v20
    v_and_b32 v20, 63, v19
    v_lshrrev_b32 v19, 6, v19
    v_lshl_or_b32 v19, v19, 7, v20
    v_and_b32 v20, 127, v19
    v_lshrrev_b32 v19, 7, v19
    v_lshl_or_b32 v19, v19, 8, v20
    v_lshlrev_b32 v19, 9, v19
    v_add_u32 v19, s29, v19
    ds_write_b32 v18, v19 offset:8192
    v_mov_b32 v8, 0
    v_mov_b32 v9, 0
    v_mov_b32 v10, 0
    v_mov_b32 v11, 0
    v_mov_b32 v12, 0
    v_mov_b32 v13, 0
    v_mov_b32 v14, 0
    v_mov_b32 v15, 0
    v_mov_b32 v16, 0xff7fffff
    v_mov_b32 v17, 0
    v_mov_b32 v38, 0
    v_mov_b32 v39, 1
    v_and_b32 v18, 0x1f0, v0
    s_waitcnt vmcnt(4)
    buffer_load_dwordx4 v[76:79], v2, s[8:11], s22 offen offset:0 nt
    s_add_u32 s28, s22, 65536
    buffer_load_dwordx4 v[80:83], v2, s[8:11], s28 offen offset:0 nt
    s_add_u32 s28, s22, 8192
    buffer_load_dwordx4 v[84:87], v2, s[8:11], s28 offen offset:0 nt
    s_add_u32 s28, s22, 73728
    buffer_load_dwordx4 v[88:91], v2, s[8:11], s28 offen offset:0 nt
    s_waitcnt vmcnt(4)
    buffer_load_dwordx4 v[92:95], v2, s[12:15], s22 offen offset:0 nt
    s_add_u32 s28, s22, 65536
    buffer_load_dwordx4 v[96:99], v2, s[12:15], s28 offen offset:0 nt
    s_add_u32 s28, s22, 8192
    buffer_load_dwordx4 v[100:103], v2, s[12:15], s28 offen offset:0 nt
    s_add_u32 s28, s22, 73728
    buffer_load_dwordx4 v[104:107], v2, s[12:15], s28 offen offset:0 nt
    s_waitcnt vmcnt(4)
    buffer_load_dwordx4 v[108:111], v2, s[8:11], s32 offen offset:0 nt
    s_add_u32 s28, s32, 65536
    buffer_load_dwordx4 v[112:115], v2, s[8:11], s28 offen offset:0 nt
    s_add_u32 s28, s32, 8192
    buffer_load_dwordx4 v[116:119], v2, s[8:11], s28 offen offset:0 nt
    s_add_u32 s28, s32, 73728
    buffer_load_dwordx4 v[120:123], v2, s[8:11], s28 offen offset:0 nt
    s_waitcnt vmcnt(4)
    buffer_load_dwordx4 v[124:127], v2, s[12:15], s32 offen offset:0 nt
    s_add_u32 s28, s32, 65536
    buffer_load_dwordx4 v[128:131], v2, s[12:15], s28 offen offset:0 nt
    s_add_u32 s28, s32, 8192
    buffer_load_dwordx4 v[132:135], v2, s[12:15], s28 offen offset:0 nt
    s_add_u32 s28, s32, 73728
    buffer_load_dwordx4 v[136:139], v2, s[12:15], s28 offen offset:0 nt
    s_waitcnt vmcnt(4)
    buffer_load_dwordx4 v[140:143], v2, s[8:11], s33 offen offset:0 nt
    s_add_u32 s28, s33, 65536
    buffer_load_dwordx4 v[144:147], v2, s[8:11], s28 offen offset:0 nt
    s_add_u32 s28, s33, 8192
    buffer_load_dwordx4 v[148:151], v2, s[8:11], s28 offen offset:0 nt
    s_add_u32 s28, s33, 73728
    buffer_load_dwordx4 v[152:155], v2, s[8:11], s28 offen offset:0 nt
    s_waitcnt vmcnt(4)
    buffer_load_dwordx4 v[156:159], v2, s[12:15], s33 offen offset:0 nt
    s_add_u32 s28, s33, 65536
    buffer_load_dwordx4 v[160:163], v2, s[12:15], s28 offen offset:0 nt
    s_add_u32 s28, s33, 8192
    buffer_load_dwordx4 v[164:167], v2, s[12:15], s28 offen offset:0 nt
    s_add_u32 s28, s33, 73728
    buffer_load_dwordx4 v[168:171], v2, s[12:15], s28 offen offset:0 nt
    s_waitcnt lgkmcnt(0)
    s_barrier
    ds_read_b128 v[4:7], v18 offset:2048
    s_mov_b64 exec, 1
    ds_add_rtn_u32 v40, v38, v39 offset:2560
    s_mov_b64 exec, -1
    s_waitcnt lgkmcnt(0)
    v_readfirstlane_b32 s20, v40
    s_nop 0
    s_lshl_b32 s24, s20, 2
    v_mov_b32 v41, s24
    ds_read_b32 v41, v41 offset:8192
    s_waitcnt vmcnt(28)
    v_dot2_f32_bf16 v18, v44, v4, 0
    v_dot2_f32_bf16 v19, v48, v4, 0
    v_dot2_f32_bf16 v20, v52, v4, 0
    v_dot2_f32_bf16 v21, v56, v4, 0
    v_dot2_f32_bf16 v18, v45, v5, v18
    v_dot2_f32_bf16 v19, v49, v5, v19
    v_dot2_f32_bf16 v20, v53, v5, v20
    v_dot2_f32_bf16 v21, v57, v5, v21
    v_dot2_f32_bf16 v18, v46, v6, v18
    v_dot2_f32_bf16 v19, v50, v6, v19
    v_dot2_f32_bf16 v20, v54, v6, v20
    v_dot2_f32_bf16 v21, v58, v6, v21
    v_dot2_f32_bf16 v18, v47, v7, v18
    v_dot2_f32_bf16 v19, v51, v7, v19
    v_dot2_f32_bf16 v20, v55, v7, v20
    v_dot2_f32_bf16 v21, v59, v7, v21
    s_waitcnt lgkmcnt(0)
    v_readfirstlane_b32 s21, v41
    s_nop 0
    s_cmp_eq_u32 s21, -1
    s_cbranch_scc1 L_wait0
L_back0:
    s_mov_b64 exec, 1
    ds_add_rtn_u32 v40, v38, v39 offset:2560
    s_mov_b64 exec, -1
    buffer_load_dwordx4 v[44:47], v2, s[8:11], s21 offen offset:0 nt
    s_add_u32 s28, s21, 65536
    buffer_load_dwordx4 v[48:51], v2, s[8:11], s28 offen offset:0 nt
    s_add_u32 s28, s21, 8192
    buffer_load_dwordx4 v[52:55], v2, s[8:11], s28 offen offset:0 nt
    s_add_u32 s28, s21, 73728
    buffer_load_dwordx4 v[56:59], v2, s[8:11], s28 offen offset:0 nt
    v_permlane16_swap_b32 v18, v19
    v_permlane16_swap_b32 v20, v21
    v_add_f32 v18, v18, v19
    v_add_f32 v20, v20, v21
    s_nop 0
    v_add_f32_dpp v22, v18, v18 row_ror:8 row_mask:0xf bank_mask:0xf
    s_nop 1
    v_add_f32_dpp v22, v20, v20 row_ror:8 row_mask:0xf bank_mask:0xc
    s_nop 1
    v_add_f32_dpp v22, v22, v22 row_half_mirror row_mask:0xf bank_mask:0xf
    s_nop 1
    v_add_f32_dpp v22, v22, v22 quad_perm:[1,0,3,2] row_mask:0xf bank_mask:0xf
    s_nop 1
    v_add_f32_dpp v22, v22, v22 quad_perm:[2,3,0,1] row_mask:0xf bank_mask:0xf
    v_cvt_pk_bf16_f32 v22, v22, v22
    v_and_b32 v22, s27, v22
    v_mul_f32 v22, s26, v22
    s_nop 1
    v_max_f32_dpp v23, v22, v22 row_ror:8 row_mask:0xf bank_mask:0xf
    v_mov_b32 v25, v23
    s_nop 1
    v_permlane16_swap_b32 v23, v25
    v_max3_f32 v23, v23, v25, v16
    v_sub_f32 v24, v16, v23
    v_sub_f32 v22, v22, v23
    v_exp_f32 v24, v24
    v_exp_f32 v22, v22
    v_mov_b32 v16, v23
    v_fma_f32 v17, v17, v24, v22
    v_mov_b32_dpp v26, v22 row_newbcast:0 row_mask:0xf bank_mask:0xf
    v_mov_b32_dpp v28, v22 row_newbcast:8 row_mask:0xf bank_mask:0xf
    v_mov_b32_dpp v27, v22 row_newbcast:0 row_mask:0xf bank_mask:0xf
    v_mov_b32_dpp v29, v22 row_newbcast:8 row_mask:0xf bank_mask:0xf
    v_pk_mul_f32 v[8:9], v[8:9], v[24:25] op_sel_hi:[1,0]
    v_pk_mul_f32 v[10:11], v[10:11], v[24:25] op_sel_hi:[1,0]
    v_pk_mul_f32 v[12:13], v[12:13], v[24:25] op_sel_hi:[1,0]
    v_pk_mul_f32 v[14:15], v[14:15], v[24:25] op_sel_hi:[1,0]
    v_permlane16_swap_b32 v26, v27
    v_permlane16_swap_b32 v28, v29
    s_waitcnt vmcnt(28)
    v_lshlrev_b32 v30, 16, v60
    v_and_b32 v31, s27, v60
    v_lshlrev_b32 v32, 16, v61
    v_and_b32 v33, s27, v61
    v_lshlrev_b32 v34, 16, v62
    v_and_b32 v35, s27, v62
    v_lshlrev_b32 v36, 16, v63
    v_and_b32 v37, s27, v63
    v_pk_fma_f32 v[8:9], v[30:31], v[26:27], v[8:9] op_sel_hi:[1,0,1]
    v_pk_fma_f32 v[10:11], v[32:33], v[26:27], v[10:11] op_sel_hi:[1,0,1]
    v_pk_fma_f32 v[12:13], v[34:35], v[26:27], v[12:13] op_sel_hi:[1,0,1]
    v_pk_fma_f32 v[14:15], v[36:37], v[26:27], v[14:15] op_sel_hi:[1,0,1]
    v_lshlrev_b32 v30, 16, v64
    v_and_b32 v31, s27, v64
    v_lshlrev_b32 v32, 16, v65
    v_and_b32 v33, s27, v65
    v_lshlrev_b32 v34, 16, v66
    v_and_b32 v35, s27, v66
    v_lshlrev_b32 v36, 16, v67
    v_and_b32 v37, s27, v67
    v_pk_fma_f32 v[8:9], v[30:31], v[26:27], v[8:9] op_sel:[0,1,0] op_sel_hi:[1,1,1]
    v_pk_fma_f32 v[10:11], v[32:33], v[26:27], v[10:11] op_sel:[0,1,0] op_sel_hi:[1,1,1]
    v_pk_fma_f32 v[12:13], v[34:35], v[26:27], v[12:13] op_sel:[0,1,0] op_sel_hi:[1,1,1]
    v_pk_fma_f32 v[14:15], v[36:37], v[26:27], v[14:15] op_sel:[0,1,0] op_sel_hi:[1,1,1]
    v_lshlrev_b32 v30, 16, v68
    v_and_b32 v31, s27, v68
    v_lshlrev_b32 v32, 16, v69
    v_and_b32 v33, s27, v69
    v_lshlrev_b32 v34, 16, v70
    v_and_b32 v35, s27, v70
    v_lshlrev_b32 v36, 16, v71
    v_and_b32 v37, s27, v71
    v_pk_fma_f32 v[8:9], v[30:31], v[28:29], v[8:9] op_sel_hi:[1,0,1]
    v_pk_fma_f32 v[10:11], v[32:33], v[28:29], v[10:11] op_sel_hi:[1,0,1]
    v_pk_fma_f32 v[12:13], v[34:35], v[28:29], v[12:13] op_sel_hi:[1,0,1]
    v_pk_fma_f32 v[14:15], v[36:37], v[28:29], v[14:15] op_sel_hi:[1,0,1]
    v_lshlrev_b32 v30, 16, v72
    v_and_b32 v31, s27, v72
    v_lshlrev_b32 v32, 16, v73
    v_and_b32 v33, s27, v73
    v_lshlrev_b32 v34, 16, v74
    v_and_b32 v35, s27, v74
    v_lshlrev_b32 v36, 16, v75
    v_and_b32 v37, s27, v75
    v_pk_fma_f32 v[8:9], v[30:31], v[28:29], v[8:9] op_sel:[0,1,0] op_sel_hi:[1,1,1]
    v_pk_fma_f32 v[10:11], v[32:33], v[28:29], v[10:11] op_sel:[0,1,0] op_sel_hi:[1,1,1]
    v_pk_fma_f32 v[12:13], v[34:35], v[28:29], v[12:13] op_sel:[0,1,0] op_sel_hi:[1,1,1]
    v_pk_fma_f32 v[14:15], v[36:37], v[28:29], v[14:15] op_sel:[0,1,0] op_sel_hi:[1,1,1]
    buffer_load_dwordx4 v[60:63], v2, s[12:15], s21 offen offset:0 nt
    s_add_u32 s28, s21, 65536
    buffer_load_dwordx4 v[64:67], v2, s[12:15], s28 offen offset:0 nt
    s_add_u32 s28, s21, 8192
    buffer_load_dwordx4 v[68:71], v2, s[12:15], s28 offen offset:0 nt
    s_add_u32 s28, s21, 73728
    buffer_load_dwordx4 v[72:75], v2, s[12:15], s28 offen offset:0 nt
    s_waitcnt lgkmcnt(0)
    v_readfirstlane_b32 s20, v40
    s_nop 0
    s_lshl_b32 s24, s20, 2
    v_mov_b32 v41, s24
    ds_read_b32 v41, v41 offset:8192
    s_waitcnt vmcnt(28)
    v_dot2_f32_bf16 v18, v76, v4, 0
    v_dot2_f32_bf16 v19, v80, v4, 0
    v_dot2_f32_bf16 v20, v84, v4, 0
    v_dot2_f32_bf16 v21, v88, v4, 0
    v_dot2_f32_bf16 v18, v77, v5, v18
    v_dot2_f32_bf16 v19, v81, v5, v19
    v_dot2_f32_bf16 v20, v85, v5, v20
    v_dot2_f32_bf16 v21, v89, v5, v21
    v_dot2_f32_bf16 v18, v78, v6, v18
    v_dot2_f32_bf16 v19, v82, v6, v19
    v_dot2_f32_bf16 v20, v86, v6, v20
    v_dot2_f32_bf16 v21, v90, v6, v21
    v_dot2_f32_bf16 v18, v79, v7, v18
    v_dot2_f32_bf16 v19, v83, v7, v19
    v_dot2_f32_bf16 v20, v87, v7, v20
    v_dot2_f32_bf16 v21, v91, v7, v21
    s_waitcnt lgkmcnt(0)
    v_readfirstlane_b32 s22, v41
    s_nop 0
    s_cmp_eq_u32 s22, -1
    s_cbranch_scc1 L_wait1
L_back1:
    s_mov_b64 exec, 1
    ds_add_rtn_u32 v40, v38, v39 offset:2560
    s_mov_b64 exec, -1
    buffer_load_dwordx4 v[76:79], v2, s[8:11], s22 offen offset:0 nt
    s_add_u32 s28, s22, 65536
    buffer_load_dwordx4 v[80:83], v2, s[8:11], s28 offen offset:0 nt
    s_add_u32 s28, s22, 8192
    buffer_load_dwordx4 v[84:87], v2, s[8:11], s28 offen offset:0 nt
    s_add_u32 s28, s22, 73728
    buffer_load_dwordx4 v[88:91], v2, s[8:11], s28 offen offset:0 nt
    v_permlane16_swap_b32 v18, v19
    v_permlane16_swap_b32 v20, v21
    v_add_f32 v18, v18, v19
    v_add_f32 v20, v20, v21
    s_nop 0
    v_add_f32_dpp v22, v18, v18 row_ror:8 row_mask:0xf bank_mask:0xf
    s_nop 1
    v_add_f32_dpp v22, v20, v20 row_ror:8 row_mask:0xf bank_mask:0xc
    s_nop 1
    v_add_f32_dpp v22, v22, v22 row_half_mirror row_mask:0xf bank_mask:0xf
    s_nop 1
    v_add_f32_dpp v22, v22, v22 quad_perm:[1,0,3,2] row_mask:0xf bank_mask:0xf
    s_nop 1
    v_add_f32_dpp v22, v22, v22 quad_perm:[2,3,0,1] row_mask:0xf bank_mask:0xf
    v_cvt_pk_bf16_f32 v22, v22, v22
    v_and_b32 v22, s27, v22
    v_mul_f32 v22, s26, v22
    s_nop 1
    v_max_f32_dpp v23, v22, v22 row_ror:8 row_mask:0xf bank_mask:0xf
    v_mov_b32 v25, v23
    s_nop 1
    v_permlane16_swap_b32 v23, v25
    v_max3_f32 v23, v23, v25, v16
    v_sub_f32 v24, v16, v23
    v_sub_f32 v22, v22, v23
    v_exp_f32 v24, v24
    v_exp_f32 v22, v22
    v_mov_b32 v16, v23
    v_fma_f32 v17, v17, v24, v22
    v_mov_b32_dpp v26, v22 row_newbcast:0 row_mask:0xf bank_mask:0xf
    v_mov_b32_dpp v28, v22 row_newbcast:8 row_mask:0xf bank_mask:0xf
    v_mov_b32_dpp v27, v22 row_newbcast:0 row_mask:0xf bank_mask:0xf
    v_mov_b32_dpp v29, v22 row_newbcast:8 row_mask:0xf bank_mask:0xf
    v_pk_mul_f32 v[8:9], v[8:9], v[24:25] op_sel_hi:[1,0]
    v_pk_mul_f32 v[10:11], v[10:11], v[24:25] op_sel_hi:[1,0]
    v_pk_mul_f32 v[12:13], v[12:13], v[24:25] op_sel_hi:[1,0]
    v_pk_mul_f32 v[14:15], v[14:15], v[24:25] op_sel_hi:[1,0]
    v_permlane16_swap_b32 v26, v27
    v_permlane16_swap_b32 v28, v29
    s_waitcnt vmcnt(28)
    v_lshlrev_b32 v30, 16, v92
    v_and_b32 v31, s27, v92
    v_lshlrev_b32 v32, 16, v93
    v_and_b32 v33, s27, v93
    v_lshlrev_b32 v34, 16, v94
    v_and_b32 v35, s27, v94
    v_lshlrev_b32 v36, 16, v95
    v_and_b32 v37, s27, v95
    v_pk_fma_f32 v[8:9], v[30:31], v[26:27], v[8:9] op_sel_hi:[1,0,1]
    v_pk_fma_f32 v[10:11], v[32:33], v[26:27], v[10:11] op_sel_hi:[1,0,1]
    v_pk_fma_f32 v[12:13], v[34:35], v[26:27], v[12:13] op_sel_hi:[1,0,1]
    v_pk_fma_f32 v[14:15], v[36:37], v[26:27], v[14:15] op_sel_hi:[1,0,1]
    v_lshlrev_b32 v30, 16, v96
    v_and_b32 v31, s27, v96
    v_lshlrev_b32 v32, 16, v97
    v_and_b32 v33, s27, v97
    v_lshlrev_b32 v34, 16, v98
    v_and_b32 v35, s27, v98
    v_lshlrev_b32 v36, 16, v99
    v_and_b32 v37, s27, v99
    v_pk_fma_f32 v[8:9], v[30:31], v[26:27], v[8:9] op_sel:[0,1,0] op_sel_hi:[1,1,1]
    v_pk_fma_f32 v[10:11], v[32:33], v[26:27], v[10:11] op_sel:[0,1,0] op_sel_hi:[1,1,1]
    v_pk_fma_f32 v[12:13], v[34:35], v[26:27], v[12:13] op_sel:[0,1,0] op_sel_hi:[1,1,1]
    v_pk_fma_f32 v[14:15], v[36:37], v[26:27], v[14:15] op_sel:[0,1,0] op_sel_hi:[1,1,1]
    v_lshlrev_b32 v30, 16, v100
    v_and_b32 v31, s27, v100
    v_lshlrev_b32 v32, 16, v101
    v_and_b32 v33, s27, v101
    v_lshlrev_b32 v34, 16, v102
    v_and_b32 v35, s27, v102
    v_lshlrev_b32 v36, 16, v103
    v_and_b32 v37, s27, v103
    v_pk_fma_f32 v[8:9], v[30:31], v[28:29], v[8:9] op_sel_hi:[1,0,1]
    v_pk_fma_f32 v[10:11], v[32:33], v[28:29], v[10:11] op_sel_hi:[1,0,1]
    v_pk_fma_f32 v[12:13], v[34:35], v[28:29], v[12:13] op_sel_hi:[1,0,1]
    v_pk_fma_f32 v[14:15], v[36:37], v[28:29], v[14:15] op_sel_hi:[1,0,1]
    v_lshlrev_b32 v30, 16, v104
    v_and_b32 v31, s27, v104
    v_lshlrev_b32 v32, 16, v105
    v_and_b32 v33, s27, v105
    v_lshlrev_b32 v34, 16, v106
    v_and_b32 v35, s27, v106
    v_lshlrev_b32 v36, 16, v107
    v_and_b32 v37, s27, v107
    v_pk_fma_f32 v[8:9], v[30:31], v[28:29], v[8:9] op_sel:[0,1,0] op_sel_hi:[1,1,1]
    v_pk_fma_f32 v[10:11], v[32:33], v[28:29], v[10:11] op_sel:[0,1,0] op_sel_hi:[1,1,1]
    v_pk_fma_f32 v[12:13], v[34:35], v[28:29], v[12:13] op_sel:[0,1,0] op_sel_hi:[1,1,1]
    v_pk_fma_f32 v[14:15], v[36:37], v[28:29], v[14:15] op_sel:[0,1,0] op_sel_hi:[1,1,1]
    buffer_load_dwordx4 v[92:95], v2, s[12:15], s22 offen offset:0 nt
    s_add_u32 s28, s22, 65536
    buffer_load_dwordx4 v[96:99], v2, s[12:15], s28 offen offset:0 nt
    s_add_u32 s28, s22, 8192
    buffer_load_dwordx4 v[100:103], v2, s[12:15], s28 offen offset:0 nt
    s_add_u32 s28, s22, 73728
    buffer_load_dwordx4 v[104:107], v2, s[12:15], s28 offen offset:0 nt
    s_waitcnt lgkmcnt(0)
    s_waitcnt vmcnt(28)
    v_dot2_f32_bf16 v18, v108, v4, 0
    v_dot2_f32_bf16 v19, v112, v4, 0
    v_dot2_f32_bf16 v20, v116, v4, 0
    v_dot2_f32_bf16 v21, v120, v4, 0
    v_dot2_f32_bf16 v18, v109, v5, v18
    v_dot2_f32_bf16 v19, v113, v5, v19
    v_dot2_f32_bf16 v20, v117, v5, v20
    v_dot2_f32_bf16 v21, v121, v5, v21
    v_dot2_f32_bf16 v18, v110, v6, v18
    v_dot2_f32_bf16 v19, v114, v6, v19
    v_dot2_f32_bf16 v20, v118, v6, v20
    v_dot2_f32_bf16 v21, v122, v6, v21
    v_dot2_f32_bf16 v18, v111, v7, v18
    v_dot2_f32_bf16 v19, v115, v7, v19
    v_dot2_f32_bf16 v20, v119, v7, v20
    v_dot2_f32_bf16 v21, v123, v7, v21
    s_nop 0
    v_permlane16_swap_b32 v18, v19
    s_nop 0
    v_permlane16_swap_b32 v20, v21
    v_add_f32 v18, v18, v19
    v_add_f32 v20, v20, v21
    s_nop 0
    v_add_f32_dpp v22, v18, v18 row_ror:8 row_mask:0xf bank_mask:0xf
    s_nop 1
    v_add_f32_dpp v22, v20, v20 row_ror:8 row_mask:0xf bank_mask:0xc
    s_nop 1
    v_add_f32_dpp v22, v22, v22 row_half_mirror row_mask:0xf bank_mask:0xf
    s_nop 1
    v_add_f32_dpp v22, v22, v22 quad_perm:[1,0,3,2] row_mask:0xf bank_mask:0xf
    s_nop 1
    v_add_f32_dpp v22, v22, v22 quad_perm:[2,3,0,1] row_mask:0xf bank_mask:0xf
    v_cvt_pk_bf16_f32 v22, v22, v22
    v_and_b32 v22, s27, v22
    v_mul_f32 v22, s26, v22
    s_nop 1
    v_max_f32_dpp v23, v22, v22 row_ror:8 row_mask:0xf bank_mask:0xf
    v_mov_b32 v25, v23
    s_nop 1
    v_permlane16_swap_b32 v23, v25
    v_max3_f32 v23, v23, v25, v16
    v_sub_f32 v24, v16, v23
    v_sub_f32 v22, v22, v23
    v_exp_f32 v24, v24
    v_exp_f32 v22, v22
    v_mov_b32 v16, v23
    v_fma_f32 v17, v17, v24, v22
    v_mov_b32_dpp v26, v22 row_newbcast:0 row_mask:0xf bank_mask:0xf
    v_mov_b32_dpp v28, v22 row_newbcast:8 row_mask:0xf bank_mask:0xf
    v_mov_b32_dpp v27, v22 row_newbcast:0 row_mask:0xf bank_mask:0xf
    v_mov_b32_dpp v29, v22 row_newbcast:8 row_mask:0xf bank_mask:0xf
    v_pk_mul_f32 v[8:9], v[8:9], v[24:25] op_sel_hi:[1,0]
    v_pk_mul_f32 v[10:11], v[10:11], v[24:25] op_sel_hi:[1,0]
    v_pk_mul_f32 v[12:13], v[12:13], v[24:25] op_sel_hi:[1,0]
    v_pk_mul_f32 v[14:15], v[14:15], v[24:25] op_sel_hi:[1,0]
    v_permlane16_swap_b32 v26, v27
    v_permlane16_swap_b32 v28, v29
    s_waitcnt vmcnt(24)
    v_lshlrev_b32 v30, 16, v124
    v_and_b32 v31, s27, v124
    v_lshlrev_b32 v32, 16, v125
    v_and_b32 v33, s27, v125
    v_lshlrev_b32 v34, 16, v126
    v_and_b32 v35, s27, v126
    v_lshlrev_b32 v36, 16, v127
    v_and_b32 v37, s27, v127
    v_pk_fma_f32 v[8:9], v[30:31], v[26:27], v[8:9] op_sel_hi:[1,0,1]
    v_pk_fma_f32 v[10:11], v[32:33], v[26:27], v[10:11] op_sel_hi:[1,0,1]
    v_pk_fma_f32 v[12:13], v[34:35], v[26:27], v[12:13] op_sel_hi:[1,0,1]
    v_pk_fma_f32 v[14:15], v[36:37], v[26:27], v[14:15] op_sel_hi:[1,0,1]
    v_lshlrev_b32 v30, 16, v128
    v_and_b32 v31, s27, v128
    v_lshlrev_b32 v32, 16, v129
    v_and_b32 v33, s27, v129
    v_lshlrev_b32 v34, 16, v130
    v_and_b32 v35, s27, v130
    v_lshlrev_b32 v36, 16, v131
    v_and_b32 v37, s27, v131
    v_pk_fma_f32 v[8:9], v[30:31], v[26:27], v[8:9] op_sel:[0,1,0] op_sel_hi:[1,1,1]
    v_pk_fma_f32 v[10:11], v[32:33], v[26:27], v[10:11] op_sel:[0,1,0] op_sel_hi:[1,1,1]
    v_pk_fma_f32 v[12:13], v[34:35], v[26:27], v[12:13] op_sel:[0,1,0] op_sel_hi:[1,1,1]
    v_pk_fma_f32 v[14:15], v[36:37], v[26:27], v[14:15] op_sel:[0,1,0] op_sel_hi:[1,1,1]
    v_lshlrev_b32 v30, 16, v132
    v_and_b32 v31, s27, v132
    v_lshlrev_b32 v32, 16, v133
    v_and_b32 v33, s27, v133
    v_lshlrev_b32 v34, 16, v134
    v_and_b32 v35, s27, v134
    v_lshlrev_b32 v36, 16, v135
    v_and_b32 v37, s27, v135
    v_pk_fma_f32 v[8:9], v[30:31], v[28:29], v[8:9] op_sel_hi:[1,0,1]
    v_pk_fma_f32 v[10:11], v[32:33], v[28:29], v[10:11] op_sel_hi:[1,0,1]
    v_pk_fma_f32 v[12:13], v[34:35], v[28:29], v[12:13] op_sel_hi:[1,0,1]
    v_pk_fma_f32 v[14:15], v[36:37], v[28:29], v[14:15] op_sel_hi:[1,0,1]
    v_lshlrev_b32 v30, 16, v136
    v_and_b32 v31, s27, v136
    v_lshlrev_b32 v32, 16, v137
    v_and_b32 v33, s27, v137
    v_lshlrev_b32 v34, 16, v138
    v_and_b32 v35, s27, v138
    v_lshlrev_b32 v36, 16, v139
    v_and_b32 v37, s27, v139
    v_pk_fma_f32 v[8:9], v[30:31], v[28:29], v[8:9] op_sel:[0,1,0] op_sel_hi:[1,1,1]
    v_pk_fma_f32 v[10:11], v[32:33], v[28:29], v[10:11] op_sel:[0,1,0] op_sel_hi:[1,1,1]
    v_pk_fma_f32 v[12:13], v[34:35], v[28:29], v[12:13] op_sel:[0,1,0] op_sel_hi:[1,1,1]
    v_pk_fma_f32 v[14:15], v[36:37], v[28:29], v[14:15] op_sel:[0,1,0] op_sel_hi:[1,1,1]
    s_waitcnt lgkmcnt(0)
    s_waitcnt vmcnt(20)
    v_dot2_f32_bf16 v18, v140, v4, 0
    v_dot2_f32_bf16 v19, v144, v4, 0
    v_dot2_f32_bf16 v20, v148, v4, 0
    v_dot2_f32_bf16 v21, v152, v4, 0
    v_dot2_f32_bf16 v18, v141, v5, v18
    v_dot2_f32_bf16 v19, v145, v5, v19
    v_dot2_f32_bf16 v20, v149, v5, v20
    v_dot2_f32_bf16 v21, v153, v5, v21
    v_dot2_f32_bf16 v18, v142, v6, v18
    v_dot2_f32_bf16 v19, v146, v6, v19
    v_dot2_f32_bf16 v20, v150, v6, v20
    v_dot2_f32_bf16 v21, v154, v6, v21
    v_dot2_f32_bf16 v18, v143, v7, v18
    v_dot2_f32_bf16 v19, v147, v7, v19
    v_dot2_f32_bf16 v20, v151, v7, v20
    v_dot2_f32_bf16 v21, v155, v7, v21
    s_nop 0
    v_permlane16_swap_b32 v18, v19
    s_nop 0
    v_permlane16_swap_b32 v20, v21
    v_add_f32 v18, v18, v19
    v_add_f32 v20, v20, v21
    s_nop 0
    v_add_f32_dpp v22, v18, v18 row_ror:8 row_mask:0xf bank_mask:0xf
    s_nop 1
    v_add_f32_dpp v22, v20, v20 row_ror:8 row_mask:0xf bank_mask:0xc
    s_nop 1
    v_add_f32_dpp v22, v22, v22 row_half_mirror row_mask:0xf bank_mask:0xf
    s_nop 1
    v_add_f32_dpp v22, v22, v22 quad_perm:[1,0,3,2] row_mask:0xf bank_mask:0xf
    s_nop 1
    v_add_f32_dpp v22, v22, v22 quad_perm:[2,3,0,1] row_mask:0xf bank_mask:0xf
    v_cvt_pk_bf16_f32 v22, v22, v22
    v_and_b32 v22, s27, v22
    v_mul_f32 v22, s26, v22
    s_nop 1
    v_max_f32_dpp v23, v22, v22 row_ror:8 row_mask:0xf bank_mask:0xf
    v_mov_b32 v25, v23
    s_nop 1
    v_permlane16_swap_b32 v23, v25
    v_max3_f32 v23, v23, v25, v16
    v_sub_f32 v24, v16, v23
    v_sub_f32 v22, v22, v23
    v_exp_f32 v24, v24
    v_exp_f32 v22, v22
    v_mov_b32 v16, v23
    v_fma_f32 v17, v17, v24, v22
    v_mov_b32_dpp v26, v22 row_newbcast:0 row_mask:0xf bank_mask:0xf
    v_mov_b32_dpp v28, v22 row_newbcast:8 row_mask:0xf bank_mask:0xf
    v_mov_b32_dpp v27, v22 row_newbcast:0 row_mask:0xf bank_mask:0xf
    v_mov_b32_dpp v29, v22 row_newbcast:8 row_mask:0xf bank_mask:0xf
    v_pk_mul_f32 v[8:9], v[8:9], v[24:25] op_sel_hi:[1,0]
    v_pk_mul_f32 v[10:11], v[10:11], v[24:25] op_sel_hi:[1,0]
    v_pk_mul_f32 v[12:13], v[12:13], v[24:25] op_sel_hi:[1,0]
    v_pk_mul_f32 v[14:15], v[14:15], v[24:25] op_sel_hi:[1,0]
    v_permlane16_swap_b32 v26, v27
    v_permlane16_swap_b32 v28, v29
    s_waitcnt vmcnt(16)
    v_lshlrev_b32 v30, 16, v156
    v_and_b32 v31, s27, v156
    v_lshlrev_b32 v32, 16, v157
    v_and_b32 v33, s27, v157
    v_lshlrev_b32 v34, 16, v158
    v_and_b32 v35, s27, v158
    v_lshlrev_b32 v36, 16, v159
    v_and_b32 v37, s27, v159
    v_pk_fma_f32 v[8:9], v[30:31], v[26:27], v[8:9] op_sel_hi:[1,0,1]
    v_pk_fma_f32 v[10:11], v[32:33], v[26:27], v[10:11] op_sel_hi:[1,0,1]
    v_pk_fma_f32 v[12:13], v[34:35], v[26:27], v[12:13] op_sel_hi:[1,0,1]
    v_pk_fma_f32 v[14:15], v[36:37], v[26:27], v[14:15] op_sel_hi:[1,0,1]
    v_lshlrev_b32 v30, 16, v160
    v_and_b32 v31, s27, v160
    v_lshlrev_b32 v32, 16, v161
    v_and_b32 v33, s27, v161
    v_lshlrev_b32 v34, 16, v162
    v_and_b32 v35, s27, v162
    v_lshlrev_b32 v36, 16, v163
    v_and_b32 v37, s27, v163
    v_pk_fma_f32 v[8:9], v[30:31], v[26:27], v[8:9] op_sel:[0,1,0] op_sel_hi:[1,1,1]
    v_pk_fma_f32 v[10:11], v[32:33], v[26:27], v[10:11] op_sel:[0,1,0] op_sel_hi:[1,1,1]
    v_pk_fma_f32 v[12:13], v[34:35], v[26:27], v[12:13] op_sel:[0,1,0] op_sel_hi:[1,1,1]
    v_pk_fma_f32 v[14:15], v[36:37], v[26:27], v[14:15] op_sel:[0,1,0] op_sel_hi:[1,1,1]
    v_lshlrev_b32 v30, 16, v164
    v_and_b32 v31, s27, v164
    v_lshlrev_b32 v32, 16, v165
    v_and_b32 v33, s27, v165
    v_lshlrev_b32 v34, 16, v166
    v_and_b32 v35, s27, v166
    v_lshlrev_b32 v36, 16, v167
    v_and_b32 v37, s27, v167
    v_pk_fma_f32 v[8:9], v[30:31], v[28:29], v[8:9] op_sel_hi:[1,0,1]
    v_pk_fma_f32 v[10:11], v[32:33], v[28:29], v[10:11] op_sel_hi:[1,0,1]
    v_pk_fma_f32 v[12:13], v[34:35], v[28:29], v[12:13] op_sel_hi:[1,0,1]
    v_pk_fma_f32 v[14:15], v[36:37], v[28:29], v[14:15] op_sel_hi:[1,0,1]
    v_lshlrev_b32 v30, 16, v168
    v_and_b32 v31, s27, v168
    v_lshlrev_b32 v32, 16, v169
    v_and_b32 v33, s27, v169
    v_lshlrev_b32 v34, 16, v170
    v_and_b32 v35, s27, v170
    v_lshlrev_b32 v36, 16, v171
    v_and_b32 v37, s27, v171
    v_pk_fma_f32 v[8:9], v[30:31], v[28:29], v[8:9] op_sel:[0,1,0] op_sel_hi:[1,1,1]
    v_pk_fma_f32 v[10:11], v[32:33], v[28:29], v[10:11] op_sel:[0,1,0] op_sel_hi:[1,1,1]
    v_pk_fma_f32 v[12:13], v[34:35], v[28:29], v[12:13] op_sel:[0,1,0] op_sel_hi:[1,1,1]
    v_pk_fma_f32 v[14:15], v[36:37], v[28:29], v[14:15] op_sel:[0,1,0] op_sel_hi:[1,1,1]
L_loop:
    s_cmp_ge_u32 s21, 33554432
    s_cbranch_scc1 L_sdone
    s_waitcnt lgkmcnt(0)
    v_readfirstlane_b32 s20, v40
    s_nop 0
    s_lshl_b32 s24, s20, 2
    v_mov_b32 v41, s24
    ds_read_b32 v41, v41 offset:8192
    s_waitcnt vmcnt(12)
    v_dot2_f32_bf16 v18, v44, v4, 0
    v_dot2_f32_bf16 v19, v48, v4, 0
    v_dot2_f32_bf16 v20, v52, v4, 0
    v_dot2_f32_bf16 v21, v56, v4, 0
    v_dot2_f32_bf16 v18, v45, v5, v18
    v_dot2_f32_bf16 v19, v49, v5, v19
    v_dot2_f32_bf16 v20, v53, v5, v20
    v_dot2_f32_bf16 v21, v57, v5, v21
    v_dot2_f32_bf16 v18, v46, v6, v18
    v_dot2_f32_bf16 v19, v50, v6, v19
    v_dot2_f32_bf16 v20, v54, v6, v20
    v_dot2_f32_bf16 v21, v58, v6, v21
    v_dot2_f32_bf16 v18, v47, v7, v18
    v_dot2_f32_bf16 v19, v51, v7, v19
    v_dot2_f32_bf16 v20, v55, v7, v20
    v_dot2_f32_bf16 v21, v59, v7, v21
    s_waitcnt lgkmcnt(0)
    v_readfirstlane_b32 s21, v41
    s_nop 0
    s_cmp_eq_u32 s21, -1
    s_cbranch_scc1 L_wait2
L_back2:
    s_mov_b64 exec, 1
    ds_add_rtn_u32 v40, v38, v39 offset:2560
    s_mov_b64 exec, -1
    buffer_load_dwordx4 v[44:47], v2, s[8:11], s21 offen offset:0 nt
    s_add_u32 s28, s21, 65536
    buffer_load_dwordx4 v[48:51], v2, s[8:11], s28 offen offset:0 nt
    s_add_u32 s28, s21, 8192
    buffer_load_dwordx4 v[52:55], v2, s[8:11], s28 offen offset:0 nt
    s_add_u32 s28, s21, 73728
    buffer_load_dwordx4 v[56:59], v2, s[8:11], s28 offen offset:0 nt
    v_permlane16_swap_b32 v18, v19
    v_permlane16_swap_b32 v20, v21
    v_add_f32 v18, v18, v19
    v_add_f32 v20, v20, v21
    s_nop 0
    v_add_f32_dpp v22, v18, v18 row_ror:8 row_mask:0xf bank_mask:0xf
    s_nop 1
    v_add_f32_dpp v22, v20, v20 row_ror:8 row_mask:0xf bank_mask:0xc
    s_nop 1
    v_add_f32_dpp v22, v22, v22 row_half_mirror row_mask:0xf bank_mask:0xf
    s_nop 1
    v_add_f32_dpp v22, v22, v22 quad_perm:[1,0,3,2] row_mask:0xf bank_mask:0xf
    s_nop 1
    v_add_f32_dpp v22, v22, v22 quad_perm:[2,3,0,1] row_mask:0xf bank_mask:0xf
    v_cvt_pk_bf16_f32 v22, v22, v22
    v_and_b32 v22, s27, v22
    v_mul_f32 v22, s26, v22
    s_nop 1
    v_max_f32_dpp v23, v22, v22 row_ror:8 row_mask:0xf bank_mask:0xf
    v_mov_b32 v25, v23
    s_nop 1
    v_permlane16_swap_b32 v23, v25
    v_max3_f32 v23, v23, v25, v16
    v_sub_f32 v24, v16, v23
    v_sub_f32 v22, v22, v23
    v_exp_f32 v24, v24
    v_exp_f32 v22, v22
    v_mov_b32 v16, v23
    v_fma_f32 v17, v17, v24, v22
    v_mov_b32_dpp v26, v22 row_newbcast:0 row_mask:0xf bank_mask:0xf
    v_mov_b32_dpp v28, v22 row_newbcast:8 row_mask:0xf bank_mask:0xf
    v_mov_b32_dpp v27, v22 row_newbcast:0 row_mask:0xf bank_mask:0xf
    v_mov_b32_dpp v29, v22 row_newbcast:8 row_mask:0xf bank_mask:0xf
    v_pk_mul_f32 v[8:9], v[8:9], v[24:25] op_sel_hi:[1,0]
    v_pk_mul_f32 v[10:11], v[10:11], v[24:25] op_sel_hi:[1,0]
    v_pk_mul_f32 v[12:13], v[12:13], v[24:25] op_sel_hi:[1,0]
    v_pk_mul_f32 v[14:15], v[14:15], v[24:25] op_sel_hi:[1,0]
    v_permlane16_swap_b32 v26, v27
    v_permlane16_swap_b32 v28, v29
    s_waitcnt vmcnt(12)
    v_lshlrev_b32 v30, 16, v60
    v_and_b32 v31, s27, v60
    v_lshlrev_b32 v32, 16, v61
    v_and_b32 v33, s27, v61
    v_lshlrev_b32 v34, 16, v62
    v_and_b32 v35, s27, v62
    v_lshlrev_b32 v36, 16, v63
    v_and_b32 v37, s27, v63
    v_pk_fma_f32 v[8:9], v[30:31], v[26:27], v[8:9] op_sel_hi:[1,0,1]
    v_pk_fma_f32 v[10:11], v[32:33], v[26:27], v[10:11] op_sel_hi:[1,0,1]
    v_pk_fma_f32 v[12:13], v[34:35], v[26:27], v[12:13] op_sel_hi:[1,0,1]
    v_pk_fma_f32 v[14:15], v[36:37], v[26:27], v[14:15] op_sel_hi:[1,0,1]
    v_lshlrev_b32 v30, 16, v64
    v_and_b32 v31, s27, v64
    v_lshlrev_b32 v32, 16, v65
    v_and_b32 v33, s27, v65
    v_lshlrev_b32 v34, 16, v66
    v_and_b32 v35, s27, v66
    v_lshlrev_b32 v36, 16, v67
    v_and_b32 v37, s27, v67
    v_pk_fma_f32 v[8:9], v[30:31], v[26:27], v[8:9] op_sel:[0,1,0] op_sel_hi:[1,1,1]
    v_pk_fma_f32 v[10:11], v[32:33], v[26:27], v[10:11] op_sel:[0,1,0] op_sel_hi:[1,1,1]
    v_pk_fma_f32 v[12:13], v[34:35], v[26:27], v[12:13] op_sel:[0,1,0] op_sel_hi:[1,1,1]
    v_pk_fma_f32 v[14:15], v[36:37], v[26:27], v[14:15] op_sel:[0,1,0] op_sel_hi:[1,1,1]
    v_lshlrev_b32 v30, 16, v68
    v_and_b32 v31, s27, v68
    v_lshlrev_b32 v32, 16, v69
    v_and_b32 v33, s27, v69
    v_lshlrev_b32 v34, 16, v70
    v_and_b32 v35, s27, v70
    v_lshlrev_b32 v36, 16, v71
    v_and_b32 v37, s27, v71
    v_pk_fma_f32 v[8:9], v[30:31], v[28:29], v[8:9] op_sel_hi:[1,0,1]
    v_pk_fma_f32 v[10:11], v[32:33], v[28:29], v[10:11] op_sel_hi:[1,0,1]
    v_pk_fma_f32 v[12:13], v[34:35], v[28:29], v[12:13] op_sel_hi:[1,0,1]
    v_pk_fma_f32 v[14:15], v[36:37], v[28:29], v[14:15] op_sel_hi:[1,0,1]
    v_lshlrev_b32 v30, 16, v72
    v_and_b32 v31, s27, v72
    v_lshlrev_b32 v32, 16, v73
    v_and_b32 v33, s27, v73
    v_lshlrev_b32 v34, 16, v74
    v_and_b32 v35, s27, v74
    v_lshlrev_b32 v36, 16, v75
    v_and_b32 v37, s27, v75
    v_pk_fma_f32 v[8:9], v[30:31], v[28:29], v[8:9] op_sel:[0,1,0] op_sel_hi:[1,1,1]
    v_pk_fma_f32 v[10:11], v[32:33], v[28:29], v[10:11] op_sel:[0,1,0] op_sel_hi:[1,1,1]
    v_pk_fma_f32 v[12:13], v[34:35], v[28:29], v[12:13] op_sel:[0,1,0] op_sel_hi:[1,1,1]
    v_pk_fma_f32 v[14:15], v[36:37], v[28:29], v[14:15] op_sel:[0,1,0] op_sel_hi:[1,1,1]
    buffer_load_dwordx4 v[60:63], v2, s[12:15], s21 offen offset:0 nt
    s_add_u32 s28, s21, 65536
    buffer_load_dwordx4 v[64:67], v2, s[12:15], s28 offen offset:0 nt
    s_add_u32 s28, s21, 8192
    buffer_load_dwordx4 v[68:71], v2, s[12:15], s28 offen offset:0 nt
    s_add_u32 s28, s21, 73728
    buffer_load_dwordx4 v[72:75], v2, s[12:15], s28 offen offset:0 nt
    s_cmp_ge_u32 s22, 33554432
    s_cbranch_scc1 L_sdone
    s_waitcnt lgkmcnt(0)
    v_readfirstlane_b32 s20, v40
    s_nop 0
    s_lshl_b32 s24, s20, 2
    v_mov_b32 v41, s24
    ds_read_b32 v41, v41 offset:8192
    s_waitcnt vmcnt(12)
    v_dot2_f32_bf16 v18, v76, v4, 0
    v_dot2_f32_bf16 v19, v80, v4, 0
    v_dot2_f32_bf16 v20, v84, v4, 0
    v_dot2_f32_bf16 v21, v88, v4, 0
    v_dot2_f32_bf16 v18, v77, v5, v18
    v_dot2_f32_bf16 v19, v81, v5, v19
    v_dot2_f32_bf16 v20, v85, v5, v20
    v_dot2_f32_bf16 v21, v89, v5, v21
    v_dot2_f32_bf16 v18, v78, v6, v18
    v_dot2_f32_bf16 v19, v82, v6, v19
    v_dot2_f32_bf16 v20, v86, v6, v20
    v_dot2_f32_bf16 v21, v90, v6, v21
    v_dot2_f32_bf16 v18, v79, v7, v18
    v_dot2_f32_bf16 v19, v83, v7, v19
    v_dot2_f32_bf16 v20, v87, v7, v20
    v_dot2_f32_bf16 v21, v91, v7, v21
    s_waitcnt lgkmcnt(0)
    v_readfirstlane_b32 s22, v41
    s_nop 0
    s_cmp_eq_u32 s22, -1
    s_cbranch_scc1 L_wait3
L_back3:
    s_mov_b64 exec, 1
    ds_add_rtn_u32 v40, v38, v39 offset:2560
    s_mov_b64 exec, -1
    buffer_load_dwordx4 v[76:79], v2, s[8:11], s22 offen offset:0 nt
    s_add_u32 s28, s22, 65536
    buffer_load_dwordx4 v[80:83], v2, s[8:11], s28 offen offset:0 nt
    s_add_u32 s28, s22, 8192
    buffer_load_dwordx4 v[84:87], v2, s[8:11], s28 offen offset:0 nt
    s_add_u32 s28, s22, 73728
    buffer_load_dwordx4 v[88:91], v2, s[8:11], s28 offen offset:0 nt
    v_permlane16_swap_b32 v18, v19
    v_permlane16_swap_b32 v20, v21
    v_add_f32 v18, v18, v19
    v_add_f32 v20, v20, v21
    s_nop 0
    v_add_f32_dpp v22, v18, v18 row_ror:8 row_mask:0xf bank_mask:0xf
    s_nop 1
    v_add_f32_dpp v22, v20, v20 row_ror:8 row_mask:0xf bank_mask:0xc
    s_nop 1
    v_add_f32_dpp v22, v22, v22 row_half_mirror row_mask:0xf bank_mask:0xf
    s_nop 1
    v_add_f32_dpp v22, v22, v22 quad_perm:[1,0,3,2] row_mask:0xf bank_mask:0xf
    s_nop 1
    v_add_f32_dpp v22, v22, v22 quad_perm:[2,3,0,1] row_mask:0xf bank_mask:0xf
    v_cvt_pk_bf16_f32 v22, v22, v22
    v_and_b32 v22, s27, v22
    v_mul_f32 v22, s26, v22
    s_nop 1
    v_max_f32_dpp v23, v22, v22 row_ror:8 row_mask:0xf bank_mask:0xf
    v_mov_b32 v25, v23
    s_nop 1
    v_permlane16_swap_b32 v23, v25
    v_max3_f32 v23, v23, v25, v16
    v_sub_f32 v24, v16, v23
    v_sub_f32 v22, v22, v23
    v_exp_f32 v24, v24
    v_exp_f32 v22, v22
    v_mov_b32 v16, v23
    v_fma_f32 v17, v17, v24, v22
    v_mov_b32_dpp v26, v22 row_newbcast:0 row_mask:0xf bank_mask:0xf
    v_mov_b32_dpp v28, v22 row_newbcast:8 row_mask:0xf bank_mask:0xf
    v_mov_b32_dpp v27, v22 row_newbcast:0 row_mask:0xf bank_mask:0xf
    v_mov_b32_dpp v29, v22 row_newbcast:8 row_mask:0xf bank_mask:0xf
    v_pk_mul_f32 v[8:9], v[8:9], v[24:25] op_sel_hi:[1,0]
    v_pk_mul_f32 v[10:11], v[10:11], v[24:25] op_sel_hi:[1,0]
    v_pk_mul_f32 v[12:13], v[12:13], v[24:25] op_sel_hi:[1,0]
    v_pk_mul_f32 v[14:15], v[14:15], v[24:25] op_sel_hi:[1,0]
    v_permlane16_swap_b32 v26, v27
    v_permlane16_swap_b32 v28, v29
    s_waitcnt vmcnt(12)
    v_lshlrev_b32 v30, 16, v92
    v_and_b32 v31, s27, v92
    v_lshlrev_b32 v32, 16, v93
    v_and_b32 v33, s27, v93
    v_lshlrev_b32 v34, 16, v94
    v_and_b32 v35, s27, v94
    v_lshlrev_b32 v36, 16, v95
    v_and_b32 v37, s27, v95
    v_pk_fma_f32 v[8:9], v[30:31], v[26:27], v[8:9] op_sel_hi:[1,0,1]
    v_pk_fma_f32 v[10:11], v[32:33], v[26:27], v[10:11] op_sel_hi:[1,0,1]
    v_pk_fma_f32 v[12:13], v[34:35], v[26:27], v[12:13] op_sel_hi:[1,0,1]
    v_pk_fma_f32 v[14:15], v[36:37], v[26:27], v[14:15] op_sel_hi:[1,0,1]
    v_lshlrev_b32 v30, 16, v96
    v_and_b32 v31, s27, v96
    v_lshlrev_b32 v32, 16, v97
    v_and_b32 v33, s27, v97
    v_lshlrev_b32 v34, 16, v98
    v_and_b32 v35, s27, v98
    v_lshlrev_b32 v36, 16, v99
    v_and_b32 v37, s27, v99
    v_pk_fma_f32 v[8:9], v[30:31], v[26:27], v[8:9] op_sel:[0,1,0] op_sel_hi:[1,1,1]
    v_pk_fma_f32 v[10:11], v[32:33], v[26:27], v[10:11] op_sel:[0,1,0] op_sel_hi:[1,1,1]
    v_pk_fma_f32 v[12:13], v[34:35], v[26:27], v[12:13] op_sel:[0,1,0] op_sel_hi:[1,1,1]
    v_pk_fma_f32 v[14:15], v[36:37], v[26:27], v[14:15] op_sel:[0,1,0] op_sel_hi:[1,1,1]
    v_lshlrev_b32 v30, 16, v100
    v_and_b32 v31, s27, v100
    v_lshlrev_b32 v32, 16, v101
    v_and_b32 v33, s27, v101
    v_lshlrev_b32 v34, 16, v102
    v_and_b32 v35, s27, v102
    v_lshlrev_b32 v36, 16, v103
    v_and_b32 v37, s27, v103
    v_pk_fma_f32 v[8:9], v[30:31], v[28:29], v[8:9] op_sel_hi:[1,0,1]
    v_pk_fma_f32 v[10:11], v[32:33], v[28:29], v[10:11] op_sel_hi:[1,0,1]
    v_pk_fma_f32 v[12:13], v[34:35], v[28:29], v[12:13] op_sel_hi:[1,0,1]
    v_pk_fma_f32 v[14:15], v[36:37], v[28:29], v[14:15] op_sel_hi:[1,0,1]
    v_lshlrev_b32 v30, 16, v104
    v_and_b32 v31, s27, v104
    v_lshlrev_b32 v32, 16, v105
    v_and_b32 v33, s27, v105
    v_lshlrev_b32 v34, 16, v106
    v_and_b32 v35, s27, v106
    v_lshlrev_b32 v36, 16, v107
    v_and_b32 v37, s27, v107
    v_pk_fma_f32 v[8:9], v[30:31], v[28:29], v[8:9] op_sel:[0,1,0] op_sel_hi:[1,1,1]
    v_pk_fma_f32 v[10:11], v[32:33], v[28:29], v[10:11] op_sel:[0,1,0] op_sel_hi:[1,1,1]
    v_pk_fma_f32 v[12:13], v[34:35], v[28:29], v[12:13] op_sel:[0,1,0] op_sel_hi:[1,1,1]
    v_pk_fma_f32 v[14:15], v[36:37], v[28:29], v[14:15] op_sel:[0,1,0] op_sel_hi:[1,1,1]
    buffer_load_dwordx4 v[92:95], v2, s[12:15], s22 offen offset:0 nt
    s_add_u32 s28, s22, 65536
    buffer_load_dwordx4 v[96:99], v2, s[12:15], s28 offen offset:0 nt
    s_add_u32 s28, s22, 8192
    buffer_load_dwordx4 v[100:103], v2, s[12:15], s28 offen offset:0 nt
    s_add_u32 s28, s22, 73728
    buffer_load_dwordx4 v[104:107], v2, s[12:15], s28 offen offset:0 nt
    s_branch L_loop
L_wait0:
    s_mov_b32 s30, 0x100000
    s_add_u32 s31, s31, 1
L_wait0_s:
    v_mov_b32 v41, s24
    ds_read_b32 v41, v41 offset:8192
    s_waitcnt lgkmcnt(0)
    v_readfirstlane_b32 s21, v41
    s_nop 0
    s_cmp_lg_u32 s21, -1
    s_cbranch_scc1 L_back0
    s_sleep 1
    s_sub_u32 s30, s30, 1
    s_cmp_lg_u32 s30, 0
    s_cbranch_scc1 L_wait0_s
    s_branch L_back0
L_wait1:
    s_mov_b32 s30, 0x100000
    s_add_u32 s31, s31, 1
L_wait1_s:
    v_mov_b32 v41, s24
    ds_read_b32 v41, v41 offset:8192
    s_waitcnt lgkmcnt(0)
    v_readfirstlane_b32 s22, v41
    s_nop 0
    s_cmp_lg_u32 s22, -1
    s_cbranch_scc1 L_back1
    s_sleep 1
    s_sub_u32 s30, s30, 1
    s_cmp_lg_u32 s30, 0
    s_cbranch_scc1 L_wait1_s
    s_branch L_back1
L_wait2:
    s_mov_b32 s30, 0x100000
    s_add_u32 s31, s31, 1
L_wait2_s:
    v_mov_b32 v41, s24
    ds_read_b32 v41, v41 offset:8192
    s_waitcnt lgkmcnt(0)
    v_readfirstlane_b32 s21, v41
    s_nop 0
    s_cmp_lg_u32 s21, -1
    s_cbranch_scc1 L_back2
    s_sleep 1
    s_sub_u32 s30, s30, 1
    s_cmp_lg_u32 s30, 0
    s_cbranch_scc1 L_wait2_s
    s_branch L_back2
L_wait3:
    s_mov_b32 s30, 0x100000
    s_add_u32 s31, s31, 1
L_wait3_s:
    v_mov_b32 v41, s24
    ds_read_b32 v41, v41 offset:8192
    s_waitcnt lgkmcnt(0)
    v_readfirstlane_b32 s22, v41
    s_nop 0
    s_cmp_lg_u32 s22, -1
    s_cbranch_scc1 L_back3
    s_sleep 1
    s_sub_u32 s30, s30, 1
    s_cmp_lg_u32 s30, 0
    s_cbranch_scc1 L_wait3_s
    s_branch L_back3
L_sdone:
L_sfin:
    v_add_f32_dpp v17, v17, v17 row_ror:8 row_mask:0xf bank_mask:0xf
    v_mov_b32 v22, v16
    v_mov_b32 v23, v16
    s_nop 1
    v_permlane32_swap_b32 v22, v23
    v_max_f32 v22, v22, v23
    v_mov_b32 v18, v17
    s_nop 1
    v_permlane16_swap_b32 v17, v18
    v_add_f32 v17, v17, v18
    v_sub_f32 v24, v16, v22
    v_exp_f32 v24, v24
    s_lshl_b32 s25, s7, 10
    s_lshl_b32 s24, s7, 3
    v_and_b32 v18, 0x1f0, v0
    v_lshlrev_b32 v18, 1, v18
    v_lshrrev_b32 v19, 9, v0
    v_lshl_add_u32 v18, v19, 4, v18
    v_add_u32 v18, s25, v18
    v_mov_b32 v20, s24
    v_pk_mul_f32 v[8:9], v[8:9], v[24:25] op_sel_hi:[1,0]
    v_pk_mul_f32 v[10:11], v[10:11], v[24:25] op_sel_hi:[1,0]
    v_pk_mul_f32 v[12:13], v[12:13], v[24:25] op_sel_hi:[1,0]
    v_pk_mul_f32 v[14:15], v[14:15], v[24:25] op_sel_hi:[1,0]
    v_mul_f32 v23, v17, v24
    v_permlane32_swap_b32 v8, v12
    v_permlane32_swap_b32 v9, v13
    v_permlane32_swap_b32 v10, v14
    v_permlane32_swap_b32 v11, v15
    v_mov_b32 v19, v23
    s_nop 1
    v_permlane32_swap_b32 v23, v19
    v_add_f32 v23, v23, v19
    v_add_f32 v8, v8, v12
    v_add_f32 v9, v9, v13
    v_add_f32 v10, v10, v14
    v_add_f32 v11, v11, v15
    ds_write_b128 v18, v[8:11] offset:4096
    s_and_b64 exec, exec, 1
    ds_write_b64 v20, v[22:23] offset:2624
    s_waitcnt lgkmcnt(0)
    s_cbranch_execz L_htail
    s_barrier
    s_waitcnt vmcnt(0)
    s_endpgm
L_helper:
    s_setprio 3
    v_lshlrev_b32 v1, 4, v0
    v_lshrrev_b32 v2, 3, v0
    v_and_b32 v3, 7, v0
    v_lshlrev_b32 v3, 4, v3
    v_lshl_add_u32 v4, v2, 13, v3
    s_lshr_b32 s6, s5, 2
    s_mul_i32 s6, s6, 112
    s_lshl_b32 s20, s6, 13
    s_lshl_b32 s24, s4, 9
    s_add_u32 s20, s20, s24
    s_and_b32 s24, s5, 3
    s_lshl_b32 s24, s24, 7
    s_add_u32 s20, s20, s24
    v_mov_b32 v5, 0
    s_mov_b32 s7, 0
    s_waitcnt lgkmcnt(0)
    s_load_dwordx2 s[30:31], s[84:85], 0
    s_mov_b32 s8, s64
    s_mov_b32 s9, s65
    s_mov_b32 s10, 896
    s_mov_b32 s11, 0x20000
    s_mov_b32 s12, s70
    s_mov_b32 s13, s71
    s_mov_b32 s14, 3670016
    s_mov_b32 s15, 0x20000
    buffer_load_dwordx4 v[8:11], v1, s[8:11], 0 offen
    buffer_load_dwordx4 v[64:67], v4, s[12:15], s20 offen nt
    s_add_u32 s20, s20, 65536
    buffer_load_dwordx4 v[68:71], v4, s[12:15], s20 offen nt
    s_add_u32 s20, s20, 65536
    buffer_load_dwordx4 v[72:75], v4, s[12:15], s20 offen nt
    s_add_u32 s20, s20, 65536
    buffer_load_dwordx4 v[76:79], v4, s[12:15], s20 offen nt
    s_add_u32 s20, s20, 65536
    buffer_load_dwordx4 v[80:83], v4, s[12:15], s20 offen nt
    s_add_u32 s20, s20, 65536
    buffer_load_dwordx4 v[84:87], v4, s[12:15], s20 offen nt
    s_add_u32 s20, s20, 65536
    buffer_load_dwordx4 v[88:91], v4, s[12:15], s20 offen nt
    s_add_u32 s20, s20, 65536
    buffer_load_dwordx4 v[92:95], v4, s[12:15], s20 offen nt
    s_add_u32 s20, s20, 65536
    buffer_load_dwordx4 v[96:99], v4, s[12:15], s20 offen nt
    s_add_u32 s20, s20, 65536
    buffer_load_dwordx4 v[100:103], v4, s[12:15], s20 offen nt
    s_add_u32 s20, s20, 65536
    buffer_load_dwordx4 v[104:107], v4, s[12:15], s20 offen nt
    s_add_u32 s20, s20, 65536
    buffer_load_dwordx4 v[108:111], v4, s[12:15], s20 offen nt
    s_add_u32 s20, s20, 65536
    buffer_load_dwordx4 v[112:115], v4, s[12:15], s20 offen nt
    s_add_u32 s20, s20, 65536
    buffer_load_dwordx4 v[116:119], v4, s[12:15], s20 offen nt
    s_barrier
    s_mov_b32 s16, s84
    s_mov_b32 s17, s85
    s_mov_b32 s18, 1572864
    s_mov_b32 s19, 0x20000
    v_mov_b32 v12, 16
    ds_write_b32 v5, v12 offset:2560
    v_lshrrev_b32 v12, 5, v0
    v_lshlrev_b32 v12, 2, v12
    v_bfe_u32 v13, v0, 4, 1
    v_lshl_add_u32 v12, v13, 1, v12
    v_bfe_u32 v13, v0, 3, 1
    v_add_u32 v12, v12, v13
    v_lshrrev_b32 v6, 1, v3
    v_add_u32 v6, v6, v12
    v_lshlrev_b32 v6, 3, v6
    v_cmp_eq_u32 s[32:33], 0, v13
    v_add_u32 v7, s6, v2
    v_lshlrev_b32 v7, 2, v7
    s_waitcnt vmcnt(14)
    v_lshlrev_b32 v16, 16, v8
    v_and_b32 v17, 0xffff0000, v8
    v_lshlrev_b32 v18, 16, v9
    v_and_b32 v19, 0xffff0000, v9
    v_lshlrev_b32 v20, 16, v10
    v_and_b32 v21, 0xffff0000, v10
    v_lshlrev_b32 v22, 16, v11
    v_and_b32 v23, 0xffff0000, v11
    v_add_f32 v24, v16, v17
    v_add_f32 v25, v18, v19
    v_add_f32 v26, v20, v21
    v_add_f32 v27, v22, v23
    v_add_f32 v24, v24, v25
    v_add_f32 v26, v26, v27
    v_add_f32 v24, v24, v26
    s_nop 1
    v_add_f32_dpp v24, v24, v24 quad_perm:[1,0,3,2] row_mask:0xf bank_mask:0xf
    s_nop 1
    v_add_f32_dpp v24, v24, v24 quad_perm:[2,3,0,1] row_mask:0xf bank_mask:0xf
    s_nop 1
    v_add_f32_dpp v24, v24, v24 row_half_mirror row_mask:0xf bank_mask:0xf
    s_nop 1
    v_add_f32_dpp v24, v24, v24 row_mirror row_mask:0xf bank_mask:0xf
    v_mov_b32 v25, v24
    s_nop 1
    v_permlane16_swap_b32 v24, v25
    v_add_f32 v24, v24, v25
    v_mov_b32 v25, v24
    s_nop 1
    v_permlane32_swap_b32 v24, v25
    v_add_f32 v24, v24, v25
    v_mul_f32 v24, 0x3b124925, v24
    v_mov_b32 v26, 0
    v_cmp_gt_u32 vcc, 56, v0
    v_sub_f32 v27, v16, v24
    v_fmac_f32 v26, v27, v27
    v_sub_f32 v27, v17, v24
    v_fmac_f32 v26, v27, v27
    v_sub_f32 v27, v18, v24
    v_fmac_f32 v26, v27, v27
    v_sub_f32 v27, v19, v24
    v_fmac_f32 v26, v27, v27
    v_sub_f32 v27, v20, v24
    v_fmac_f32 v26, v27, v27
    v_sub_f32 v27, v21, v24
    v_fmac_f32 v26, v27, v27
    v_sub_f32 v27, v22, v24
    v_fmac_f32 v26, v27, v27
    v_sub_f32 v27, v23, v24
    v_fmac_f32 v26, v27, v27
    v_cndmask_b32 v26, 0, v26, vcc
    s_nop 1
    v_add_f32_dpp v26, v26, v26 quad_perm:[1,0,3,2] row_mask:0xf bank_mask:0xf
    s_nop 1
    v_add_f32_dpp v26, v26, v26 quad_perm:[2,3,0,1] row_mask:0xf bank_mask:0xf
    s_nop 1
    v_add_f32_dpp v26, v26, v26 row_half_mirror row_mask:0xf bank_mask:0xf
    s_nop 1
    v_add_f32_dpp v26, v26, v26 row_mirror row_mask:0xf bank_mask:0xf
    v_mov_b32 v25, v26
    s_nop 1
    v_permlane16_swap_b32 v26, v25
    v_add_f32 v26, v26, v25
    v_mov_b32 v25, v26
    s_nop 1
    v_permlane32_swap_b32 v26, v25
    v_add_f32 v26, v26, v25
    v_mul_f32 v26, 0x3b124925, v26
    v_cvt_pk_bf16_f32 v24, v24, v24
    v_and_b32 v24, 0xffff0000, v24
    v_cvt_pk_bf16_f32 v26, v26, v26
    v_and_b32 v26, 0xffff0000, v26
    v_add_f32 v26, 0x3727c5ac, v26
    v_cvt_pk_bf16_f32 v26, v26, v26
    v_and_b32 v26, 0xffff0000, v26
    v_sqrt_f32 v26, v26
    s_nop 0
    v_cvt_pk_bf16_f32 v26, v26, v26
    v_and_b32 v26, 0xffff0000, v26
    v_rcp_f32 v27, v26
    v_sub_f32 v16, v16, v24
    v_sub_f32 v17, v17, v24
    v_sub_f32 v18, v18, v24
    v_sub_f32 v19, v19, v24
    v_sub_f32 v20, v20, v24
    v_sub_f32 v21, v21, v24
    v_sub_f32 v22, v22, v24
    v_sub_f32 v23, v23, v24
    v_cvt_pk_bf16_f32 v16, v16, v16
    v_and_b32 v16, 0xffff0000, v16
    v_cvt_pk_bf16_f32 v17, v17, v17
    v_and_b32 v17, 0xffff0000, v17
    v_cvt_pk_bf16_f32 v18, v18, v18
    v_and_b32 v18, 0xffff0000, v18
    v_cvt_pk_bf16_f32 v19, v19, v19
    v_and_b32 v19, 0xffff0000, v19
    v_cvt_pk_bf16_f32 v20, v20, v20
    v_and_b32 v20, 0xffff0000, v20
    v_cvt_pk_bf16_f32 v21, v21, v21
    v_and_b32 v21, 0xffff0000, v21
    v_cvt_pk_bf16_f32 v22, v22, v22
    v_and_b32 v22, 0xffff0000, v22
    v_cvt_pk_bf16_f32 v23, v23, v23
    v_and_b32 v23, 0xffff0000, v23
    v_mul_f32 v28, v16, v27
    v_fma_f32 v29, -v28, v26, v16
    v_fma_f32 v16, v29, v27, v28
    v_mul_f32 v28, v17, v27
    v_fma_f32 v29, -v28, v26, v17
    v_fma_f32 v17, v29, v27, v28
    v_mul_f32 v28, v18, v27
    v_fma_f32 v29, -v28, v26, v18
    v_fma_f32 v18, v29, v27, v28
    v_mul_f32 v28, v19, v27
    v_fma_f32 v29, -v28, v26, v19
    v_fma_f32 v19, v29, v27, v28
    v_mul_f32 v28, v20, v27
    v_fma_f32 v29, -v28, v26, v20
    v_fma_f32 v20, v29, v27, v28
    v_mul_f32 v28, v21, v27
    v_fma_f32 v29, -v28, v26, v21
    v_fma_f32 v21, v29, v27, v28
    v_mul_f32 v28, v22, v27
    v_fma_f32 v29, -v28, v26, v22
    v_fma_f32 v22, v29, v27, v28
    v_mul_f32 v28, v23, v27
    v_fma_f32 v29, -v28, v26, v23
    v_fma_f32 v23, v29, v27, v28
    v_cvt_pk_bf16_f32 v16, v16, v16
    v_and_b32 v16, 0xffff0000, v16
    v_cvt_pk_bf16_f32 v17, v17, v17
    v_and_b32 v17, 0xffff0000, v17
    v_cvt_pk_bf16_f32 v18, v18, v18
    v_and_b32 v18, 0xffff0000, v18
    v_cvt_pk_bf16_f32 v19, v19, v19
    v_and_b32 v19, 0xffff0000, v19
    v_cvt_pk_bf16_f32 v20, v20, v20
    v_and_b32 v20, 0xffff0000, v20
    v_cvt_pk_bf16_f32 v21, v21, v21
    v_and_b32 v21, 0xffff0000, v21
    v_cvt_pk_bf16_f32 v22, v22, v22
    v_and_b32 v22, 0xffff0000, v22
    v_cvt_pk_bf16_f32 v23, v23, v23
    v_and_b32 v23, 0xffff0000, v23
    v_lshlrev_b32 v28, 5, v0
    ds_write_b128 v28, v[16:19] offset:0
    ds_write_b128 v28, v[20:23] offset:16
    s_nop 1
    v_mov_b32 v16, 0
    v_mov_b32 v17, 0
    v_mov_b32 v18, 0
    v_mov_b32 v19, 0
    v_mov_b32 v20, 0
    v_mov_b32 v21, 0
    v_mov_b32 v22, 0
    v_mov_b32 v23, 0
    ds_read2_b32 v[32:33], v7 offset0:0 offset1:8
    ds_read2_b32 v[34:35], v7 offset0:16 offset1:24
    ds_read2_b32 v[36:37], v7 offset0:32 offset1:40
    ds_read2_b32 v[38:39], v7 offset0:48 offset1:56
    ds_read2_b32 v[40:41], v7 offset0:64 offset1:72
    ds_read2_b32 v[42:43], v7 offset0:80 offset1:88
    ds_read2_b32 v[44:45], v7 offset0:96 offset1:104
    s_waitcnt lgkmcnt(0)
    v_lshrrev_b32 v48, 16, v32
    v_lshrrev_b32 v49, 16, v33
    v_lshrrev_b32 v50, 16, v34
    v_lshrrev_b32 v51, 16, v35
    v_lshrrev_b32 v52, 16, v36
    v_lshrrev_b32 v53, 16, v37
    v_lshrrev_b32 v54, 16, v38
    v_lshrrev_b32 v55, 16, v39
    v_lshrrev_b32 v56, 16, v40
    v_lshrrev_b32 v57, 16, v41
    v_lshrrev_b32 v58, 16, v42
    v_lshrrev_b32 v59, 16, v43
    v_lshrrev_b32 v60, 16, v44
    v_lshrrev_b32 v61, 16, v45
    s_waitcnt vmcnt(13)
    v_dot2c_f32_bf16 v16, v64, v48
    v_dot2c_f32_bf16 v17, v64, v32
    v_dot2c_f32_bf16 v18, v65, v48
    v_dot2c_f32_bf16 v19, v65, v32
    v_dot2c_f32_bf16 v20, v66, v48
    v_dot2c_f32_bf16 v21, v66, v32
    v_dot2c_f32_bf16 v22, v67, v48
    v_dot2c_f32_bf16 v23, v67, v32
    s_waitcnt vmcnt(12)
    v_dot2c_f32_bf16 v16, v68, v49
    v_dot2c_f32_bf16 v17, v68, v33
    v_dot2c_f32_bf16 v18, v69, v49
    v_dot2c_f32_bf16 v19, v69, v33
    v_dot2c_f32_bf16 v20, v70, v49
    v_dot2c_f32_bf16 v21, v70, v33
    v_dot2c_f32_bf16 v22, v71, v49
    v_dot2c_f32_bf16 v23, v71, v33
    s_waitcnt vmcnt(11)
    v_dot2c_f32_bf16 v16, v72, v50
    v_dot2c_f32_bf16 v17, v72, v34
    v_dot2c_f32_bf16 v18, v73, v50
    v_dot2c_f32_bf16 v19, v73, v34
    v_dot2c_f32_bf16 v20, v74, v50
    v_dot2c_f32_bf16 v21, v74, v34
    v_dot2c_f32_bf16 v22, v75, v50
    v_dot2c_f32_bf16 v23, v75, v34
    s_waitcnt vmcnt(10)
    v_dot2c_f32_bf16 v16, v76, v51
    v_dot2c_f32_bf16 v17, v76, v35
    v_dot2c_f32_bf16 v18, v77, v51
    v_dot2c_f32_bf16 v19, v77, v35
    v_dot2c_f32_bf16 v20, v78, v51
    v_dot2c_f32_bf16 v21, v78, v35
    v_dot2c_f32_bf16 v22, v79, v51
    v_dot2c_f32_bf16 v23, v79, v35
    s_waitcnt vmcnt(9)
    v_dot2c_f32_bf16 v16, v80, v52
    v_dot2c_f32_bf16 v17, v80, v36
    v_dot2c_f32_bf16 v18, v81, v52
    v_dot2c_f32_bf16 v19, v81, v36
    v_dot2c_f32_bf16 v20, v82, v52
    v_dot2c_f32_bf16 v21, v82, v36
    v_dot2c_f32_bf16 v22, v83, v52
    v_dot2c_f32_bf16 v23, v83, v36
    s_waitcnt vmcnt(8)
    v_dot2c_f32_bf16 v16, v84, v53
    v_dot2c_f32_bf16 v17, v84, v37
    v_dot2c_f32_bf16 v18, v85, v53
    v_dot2c_f32_bf16 v19, v85, v37
    v_dot2c_f32_bf16 v20, v86, v53
    v_dot2c_f32_bf16 v21, v86, v37
    v_dot2c_f32_bf16 v22, v87, v53
    v_dot2c_f32_bf16 v23, v87, v37
    s_waitcnt vmcnt(7)
    v_dot2c_f32_bf16 v16, v88, v54
    v_dot2c_f32_bf16 v17, v88, v38
    v_dot2c_f32_bf16 v18, v89, v54
    v_dot2c_f32_bf16 v19, v89, v38
    v_dot2c_f32_bf16 v20, v90, v54
    v_dot2c_f32_bf16 v21, v90, v38
    v_dot2c_f32_bf16 v22, v91, v54
    v_dot2c_f32_bf16 v23, v91, v38
    s_waitcnt vmcnt(6)
    v_dot2c_f32_bf16 v16, v92, v55
    v_dot2c_f32_bf16 v17, v92, v39
    v_dot2c_f32_bf16 v18, v93, v55
    v_dot2c_f32_bf16 v19, v93, v39
    v_dot2c_f32_bf16 v20, v94, v55
    v_dot2c_f32_bf16 v21, v94, v39
    v_dot2c_f32_bf16 v22, v95, v55
    v_dot2c_f32_bf16 v23, v95, v39
    s_waitcnt vmcnt(5)
    v_dot2c_f32_bf16 v16, v96, v56
    v_dot2c_f32_bf16 v17, v96, v40
    v_dot2c_f32_bf16 v18, v97, v56
    v_dot2c_f32_bf16 v19, v97, v40
    v_dot2c_f32_bf16 v20, v98, v56
    v_dot2c_f32_bf16 v21, v98, v40
    v_dot2c_f32_bf16 v22, v99, v56
    v_dot2c_f32_bf16 v23, v99, v40
    s_waitcnt vmcnt(4)
    v_dot2c_f32_bf16 v16, v100, v57
    v_dot2c_f32_bf16 v17, v100, v41
    v_dot2c_f32_bf16 v18, v101, v57
    v_dot2c_f32_bf16 v19, v101, v41
    v_dot2c_f32_bf16 v20, v102, v57
    v_dot2c_f32_bf16 v21, v102, v41
    v_dot2c_f32_bf16 v22, v103, v57
    v_dot2c_f32_bf16 v23, v103, v41
    s_waitcnt vmcnt(3)
    v_dot2c_f32_bf16 v16, v104, v58
    v_dot2c_f32_bf16 v17, v104, v42
    v_dot2c_f32_bf16 v18, v105, v58
    v_dot2c_f32_bf16 v19, v105, v42
    v_dot2c_f32_bf16 v20, v106, v58
    v_dot2c_f32_bf16 v21, v106, v42
    v_dot2c_f32_bf16 v22, v107, v58
    v_dot2c_f32_bf16 v23, v107, v42
    s_waitcnt vmcnt(2)
    v_dot2c_f32_bf16 v16, v108, v59
    v_dot2c_f32_bf16 v17, v108, v43
    v_dot2c_f32_bf16 v18, v109, v59
    v_dot2c_f32_bf16 v19, v109, v43
    v_dot2c_f32_bf16 v20, v110, v59
    v_dot2c_f32_bf16 v21, v110, v43
    v_dot2c_f32_bf16 v22, v111, v59
    v_dot2c_f32_bf16 v23, v111, v43
    s_waitcnt vmcnt(1)
    v_dot2c_f32_bf16 v16, v112, v60
    v_dot2c_f32_bf16 v17, v112, v44
    v_dot2c_f32_bf16 v18, v113, v60
    v_dot2c_f32_bf16 v19, v113, v44
    v_dot2c_f32_bf16 v20, v114, v60
    v_dot2c_f32_bf16 v21, v114, v44
    v_dot2c_f32_bf16 v22, v115, v60
    v_dot2c_f32_bf16 v23, v115, v44
    s_waitcnt vmcnt(0)
    v_dot2c_f32_bf16 v16, v116, v61
    v_dot2c_f32_bf16 v17, v116, v45
    v_dot2c_f32_bf16 v18, v117, v61
    v_dot2c_f32_bf16 v19, v117, v45
    v_dot2c_f32_bf16 v20, v118, v61
    v_dot2c_f32_bf16 v21, v118, v45
    v_dot2c_f32_bf16 v22, v119, v61
    v_dot2c_f32_bf16 v23, v119, v45
    s_mul_i32 s30, s30, 1664525
    s_add_u32 s30, s30, 1013904223
    s_mul_i32 s31, s31, 22695477
    s_add_u32 s31, s31, 1
    v_mov_b32 v25, s31
    v_mov_b32 v26, s30
    v_cndmask_b32 v25, v25, v26, s[32:33]
    v_permlane32_swap_b32 v16, v20
    v_permlane32_swap_b32 v17, v21
    v_permlane32_swap_b32 v18, v22
    v_permlane32_swap_b32 v19, v23
    v_add_f32 v16, v16, v20
    v_add_f32 v17, v17, v21
    v_add_f32 v18, v18, v22
    v_add_f32 v19, v19, v23
    s_nop 0
    v_permlane16_swap_b32 v16, v18
    v_permlane16_swap_b32 v17, v19
    v_add_f32 v16, v16, v18
    v_add_f32 v17, v17, v19
    s_nop 0
    v_add_f32_dpp v24, v16, v16 row_ror:8 row_mask:0xf bank_mask:0xf
    s_nop 1
    v_add_f32_dpp v24, v17, v17 row_ror:8 row_mask:0xf bank_mask:0xc
    s_lshl_b32 s20, s2, 9
    s_add_u32 s20, s20, 131072
    buffer_store_dwordx2 v[24:25], v6, s[16:19], s20 offen sc1
    s_lshl_b32 s20, s4, 13
    s_add_u32 s20, s20, 131072
    s_add_u32 s21, s20, 4096
    s_mov_b32 s24, 0x40000
    s_waitcnt vmcnt(0)
L_qpoll:
    buffer_load_dwordx4 v[64:67], v1, s[16:19], s20 offen offset:0 sc1
    buffer_load_dwordx4 v[68:71], v1, s[16:19], s20 offen offset:1024 sc1
    buffer_load_dwordx4 v[72:75], v1, s[16:19], s20 offen offset:2048 sc1
    buffer_load_dwordx4 v[76:79], v1, s[16:19], s20 offen offset:3072 sc1
    buffer_load_dwordx4 v[80:83], v1, s[16:19], s21 offen offset:0 sc1
    buffer_load_dwordx4 v[84:87], v1, s[16:19], s21 offen offset:1024 sc1
    buffer_load_dwordx4 v[88:91], v1, s[16:19], s21 offen offset:2048 sc1
    buffer_load_dwordx4 v[92:95], v1, s[16:19], s21 offen offset:3072 sc1
    s_waitcnt vmcnt(0)
    v_mov_b32 v16, 0
    v_xor_b32 v17, s30, v65
    v_xor_b32 v18, s31, v67
    v_or3_b32 v16, v16, v17, v18
    v_xor_b32 v17, s30, v69
    v_xor_b32 v18, s31, v71
    v_or3_b32 v16, v16, v17, v18
    v_xor_b32 v17, s30, v73
    v_xor_b32 v18, s31, v75
    v_or3_b32 v16, v16, v17, v18
    v_xor_b32 v17, s30, v77
    v_xor_b32 v18, s31, v79
    v_or3_b32 v16, v16, v17, v18
    v_xor_b32 v17, s30, v81
    v_xor_b32 v18, s31, v83
    v_or3_b32 v16, v16, v17, v18
    v_xor_b32 v17, s30, v85
    v_xor_b32 v18, s31, v87
    v_or3_b32 v16, v16, v17, v18
    v_xor_b32 v17, s30, v89
    v_xor_b32 v18, s31, v91
    v_or3_b32 v16, v16, v17, v18
    v_xor_b32 v17, s30, v93
    v_xor_b32 v18, s31, v95
    v_or3_b32 v16, v16, v17, v18
    v_cmp_ne_u32 vcc, 0, v16
    s_cbranch_vccz L_qok
    s_sub_u32 s24, s24, 1
    s_cmp_lg_u32 s24, 0
    s_cbranch_scc1 L_qpoll
L_qok:
    v_add_f32 v64, v64, v72
    v_add_f32 v80, v80, v88
    v_add_f32 v64, v64, v80
    v_add_f32 v66, v66, v74
    v_add_f32 v82, v82, v90
    v_add_f32 v66, v66, v82
    v_cvt_pk_bf16_f32 v16, v64, v66
    v_add_f32 v68, v68, v76
    v_add_f32 v84, v84, v92
    v_add_f32 v68, v68, v84
    v_add_f32 v70, v70, v78
    v_add_f32 v86, v86, v94
    v_add_f32 v70, v70, v86
    v_cvt_pk_bf16_f32 v17, v68, v70
    v_lshlrev_b32 v18, 2, v0
    ds_write_b32 v18, v16 offset:2048
    ds_write_b32 v18, v17 offset:2304
    s_waitcnt lgkmcnt(0)
    s_barrier
    s_setprio 0
    v_mov_b32 v16, -1
    v_mov_b32 v17, -1
    v_mov_b32 v18, -1
    v_mov_b32 v19, -1
    s_lshl_b32 s20, s2, 12
    s_add_u32 s20, s20, 1048576
    s_cmp_lt_u32 s2, 112
    s_cselect_b32 s20, s20, 2130706432
    buffer_store_dwordx4 v[16:19], v1, s[16:19], s20 offen offset:0 sc1
    buffer_store_dwordx4 v[16:19], v1, s[16:19], s20 offen offset:1024 sc1
    buffer_store_dwordx4 v[16:19], v1, s[16:19], s20 offen offset:2048 sc1
    buffer_store_dwordx4 v[16:19], v1, s[16:19], s20 offen offset:3072 sc1
    s_lshl_b32 s34, s2, 10
    s_add_u32 s34, s34, 262144
    s_lshl_b32 s35, s2, 7
    s_add_u32 s35, s35, 524288
    s_mul_i32 s33, s4, 4096
    s_add_u32 s33, s33, 65536
    s_cmp_eq_u32 s5, 0
    s_cselect_b32 s36, s33, 2130706432
    buffer_store_dwordx4 v[16:19], v1, s[16:19], s34 offen sc1
    s_mov_b64 exec, 0xff
    buffer_store_dwordx4 v[16:19], v1, s[16:19], s35 offen sc1
    s_mov_b64 exec, 1
    buffer_store_dword v5, v5, s[16:19], s36 offen sc1
    s_mov_b64 exec, -1
    s_mov_b32 s12, s72
    s_mov_b32 s13, s73
    s_mov_b32 s14, 3670016
    s_mov_b32 s15, 0x20000
    s_lshl_b32 s20, s2, 4
    s_mul_i32 s20, s20, 896
    v_mov_b32 v26, 2130706432
    v_cmp_gt_u32 vcc, 56, v0
    s_nop 1
    v_cndmask_b32 v26, v26, v1, vcc
    s_mov_b32 s44, s82
    s_mov_b32 s45, s83
    s_mov_b32 s46, 256
    s_mov_b32 s47, 0x20000
    s_and_b32 s24, s4, 3
    s_lshl_b32 s24, s24, 1
    s_and_b32 s25, s5, 7
    s_cmp_lg_u32 s24, s25
    s_cbranch_scc1 L_noffn
    s_lshl_b32 s21, s4, 1
    s_lshr_b32 s24, s5, 3
    s_add_u32 s21, s21, s24
    s_cmp_ge_u32 s21, 28
    s_cbranch_scc1 L_noffn
    s_mov_b32 s8, s76
    s_mov_b32 s9, s77
    s_mov_b32 s10, 1605632
    s_mov_b32 s11, 0x20000
    s_mov_b32 s36, s78
    s_mov_b32 s37, s79
    s_mov_b32 s38, 1605632
    s_mov_b32 s39, 0x20000
    v_mul_u32_u24 v4, 3584, v2
    v_add_u32 v4, v4, v3
    v_lshlrev_b32 v7, 2, v2
    s_lshl_b32 s22, s21, 7
    s_mov_b32 s23, 0
    v_mov_b32 v16, 0
    v_mov_b32 v17, 0
    v_mov_b32 v18, 0
    v_mov_b32 v19, 0
    v_mov_b32 v20, 0
    v_mov_b32 v21, 0
    v_mov_b32 v22, 0
    v_mov_b32 v23, 0
L_ffn1:
    buffer_load_dwordx4 v[64:67], v4, s[8:11], s22 offen nt
    s_add_u32 s22, s22, 28672
    buffer_load_dwordx4 v[68:71], v4, s[8:11], s22 offen nt
    s_add_u32 s22, s22, 28672
    buffer_load_dwordx4 v[72:75], v4, s[8:11], s22 offen nt
    s_add_u32 s22, s22, 28672
    buffer_load_dwordx4 v[76:79], v4, s[8:11], s22 offen nt
    s_add_u32 s22, s22, 28672
    buffer_load_dwordx4 v[80:83], v4, s[8:11], s22 offen nt
    s_add_u32 s22, s22, 28672
    buffer_load_dwordx4 v[84:87], v4, s[8:11], s22 offen nt
    s_add_u32 s22, s22, 28672
    buffer_load_dwordx4 v[88:91], v4, s[8:11], s22 offen nt
    s_add_u32 s22, s22, 28672
    buffer_load_dwordx4 v[92:95], v4, s[8:11], s22 offen nt
    s_add_u32 s22, s22, 28672
    buffer_load_dwordx4 v[96:99], v4, s[8:11], s22 offen nt
    s_add_u32 s22, s22, 28672
    buffer_load_dwordx4 v[100:103], v4, s[8:11], s22 offen nt
    s_add_u32 s22, s22, 28672
    buffer_load_dwordx4 v[104:107], v4, s[8:11], s22 offen nt
    s_add_u32 s22, s22, 28672
    buffer_load_dwordx4 v[108:111], v4, s[8:11], s22 offen nt
    s_add_u32 s22, s22, 28672
    buffer_load_dwordx4 v[112:115], v4, s[8:11], s22 offen nt
    s_add_u32 s22, s22, 28672
    buffer_load_dwordx4 v[116:119], v4, s[8:11], s22 offen nt
    s_add_u32 s22, s22, 28672
    ds_read2_b32 v[32:33], v7 offset0:0 offset1:8
    ds_read2_b32 v[34:35], v7 offset0:16 offset1:24
    ds_read2_b32 v[36:37], v7 offset0:32 offset1:40
    ds_read2_b32 v[38:39], v7 offset0:48 offset1:56
    ds_read2_b32 v[40:41], v7 offset0:64 offset1:72
    ds_read2_b32 v[42:43], v7 offset0:80 offset1:88
    ds_read2_b32 v[44:45], v7 offset0:96 offset1:104
    s_waitcnt lgkmcnt(0)
    v_lshrrev_b32 v48, 16, v32
    v_lshrrev_b32 v49, 16, v33
    v_lshrrev_b32 v50, 16, v34
    v_lshrrev_b32 v51, 16, v35
    v_lshrrev_b32 v52, 16, v36
    v_lshrrev_b32 v53, 16, v37
    v_lshrrev_b32 v54, 16, v38
    v_lshrrev_b32 v55, 16, v39
    v_lshrrev_b32 v56, 16, v40
    v_lshrrev_b32 v57, 16, v41
    v_lshrrev_b32 v58, 16, v42
    v_lshrrev_b32 v59, 16, v43
    v_lshrrev_b32 v60, 16, v44
    v_lshrrev_b32 v61, 16, v45
    s_waitcnt vmcnt(13)
    v_dot2c_f32_bf16 v16, v64, v48
    v_dot2c_f32_bf16 v17, v64, v32
    v_dot2c_f32_bf16 v18, v65, v48
    v_dot2c_f32_bf16 v19, v65, v32
    v_dot2c_f32_bf16 v20, v66, v48
    v_dot2c_f32_bf16 v21, v66, v32
    v_dot2c_f32_bf16 v22, v67, v48
    v_dot2c_f32_bf16 v23, v67, v32
    s_waitcnt vmcnt(12)
    v_dot2c_f32_bf16 v16, v68, v49
    v_dot2c_f32_bf16 v17, v68, v33
    v_dot2c_f32_bf16 v18, v69, v49
    v_dot2c_f32_bf16 v19, v69, v33
    v_dot2c_f32_bf16 v20, v70, v49
    v_dot2c_f32_bf16 v21, v70, v33
    v_dot2c_f32_bf16 v22, v71, v49
    v_dot2c_f32_bf16 v23, v71, v33
    s_waitcnt vmcnt(11)
    v_dot2c_f32_bf16 v16, v72, v50
    v_dot2c_f32_bf16 v17, v72, v34
    v_dot2c_f32_bf16 v18, v73, v50
    v_dot2c_f32_bf16 v19, v73, v34
    v_dot2c_f32_bf16 v20, v74, v50
    v_dot2c_f32_bf16 v21, v74, v34
    v_dot2c_f32_bf16 v22, v75, v50
    v_dot2c_f32_bf16 v23, v75, v34
    s_waitcnt vmcnt(10)
    v_dot2c_f32_bf16 v16, v76, v51
    v_dot2c_f32_bf16 v17, v76, v35
    v_dot2c_f32_bf16 v18, v77, v51
    v_dot2c_f32_bf16 v19, v77, v35
    v_dot2c_f32_bf16 v20, v78, v51
    v_dot2c_f32_bf16 v21, v78, v35
    v_dot2c_f32_bf16 v22, v79, v51
    v_dot2c_f32_bf16 v23, v79, v35
    s_waitcnt vmcnt(9)
    v_dot2c_f32_bf16 v16, v80, v52
    v_dot2c_f32_bf16 v17, v80, v36
    v_dot2c_f32_bf16 v18, v81, v52
    v_dot2c_f32_bf16 v19, v81, v36
    v_dot2c_f32_bf16 v20, v82, v52
    v_dot2c_f32_bf16 v21, v82, v36
    v_dot2c_f32_bf16 v22, v83, v52
    v_dot2c_f32_bf16 v23, v83, v36
    s_waitcnt vmcnt(8)
    v_dot2c_f32_bf16 v16, v84, v53
    v_dot2c_f32_bf16 v17, v84, v37
    v_dot2c_f32_bf16 v18, v85, v53
    v_dot2c_f32_bf16 v19, v85, v37
    v_dot2c_f32_bf16 v20, v86, v53
    v_dot2c_f32_bf16 v21, v86, v37
    v_dot2c_f32_bf16 v22, v87, v53
    v_dot2c_f32_bf16 v23, v87, v37
    s_waitcnt vmcnt(7)
    v_dot2c_f32_bf16 v16, v88, v54
    v_dot2c_f32_bf16 v17, v88, v38
    v_dot2c_f32_bf16 v18, v89, v54
    v_dot2c_f32_bf16 v19, v89, v38
    v_dot2c_f32_bf16 v20, v90, v54
    v_dot2c_f32_bf16 v21, v90, v38
    v_dot2c_f32_bf16 v22, v91, v54
    v_dot2c_f32_bf16 v23, v91, v38
    s_waitcnt vmcnt(6)
    v_dot2c_f32_bf16 v16, v92, v55
    v_dot2c_f32_bf16 v17, v92, v39
    v_dot2c_f32_bf16 v18, v93, v55
    v_dot2c_f32_bf16 v19, v93, v39
    v_dot2c_f32_bf16 v20, v94, v55
    v_dot2c_f32_bf16 v21, v94, v39
    v_dot2c_f32_bf16 v22, v95, v55
    v_dot2c_f32_bf16 v23, v95, v39
    s_waitcnt vmcnt(5)
    v_dot2c_f32_bf16 v16, v96, v56
    v_dot2c_f32_bf16 v17, v96, v40
    v_dot2c_f32_bf16 v18, v97, v56
    v_dot2c_f32_bf16 v19, v97, v40
    v_dot2c_f32_bf16 v20, v98, v56
    v_dot2c_f32_bf16 v21, v98, v40
    v_dot2c_f32_bf16 v22, v99, v56
    v_dot2c_f32_bf16 v23, v99, v40
    s_waitcnt vmcnt(4)
    v_dot2c_f32_bf16 v16, v100, v57
    v_dot2c_f32_bf16 v17, v100, v41
    v_dot2c_f32_bf16 v18, v101, v57
    v_dot2c_f32_bf16 v19, v101, v41
    v_dot2c_f32_bf16 v20, v102, v57
    v_dot2c_f32_bf16 v21, v102, v41
    v_dot2c_f32_bf16 v22, v103, v57
    v_dot2c_f32_bf16 v23, v103, v41
    s_waitcnt vmcnt(3)
    v_dot2c_f32_bf16 v16, v104, v58
    v_dot2c_f32_bf16 v17, v104, v42
    v_dot2c_f32_bf16 v18, v105, v58
    v_dot2c_f32_bf16 v19, v105, v42
    v_dot2c_f32_bf16 v20, v106, v58
    v_dot2c_f32_bf16 v21, v106, v42
    v_dot2c_f32_bf16 v22, v107, v58
    v_dot2c_f32_bf16 v23, v107, v42
    s_waitcnt vmcnt(2)
    v_dot2c_f32_bf16 v16, v108, v59
    v_dot2c_f32_bf16 v17, v108, v43
    v_dot2c_f32_bf16 v18, v109, v59
    v_dot2c_f32_bf16 v19, v109, v43
    v_dot2c_f32_bf16 v20, v110, v59
    v_dot2c_f32_bf16 v21, v110, v43
    v_dot2c_f32_bf16 v22, v111, v59
    v_dot2c_f32_bf16 v23, v111, v43
    s_waitcnt vmcnt(1)
    v_dot2c_f32_bf16 v16, v112, v60
    v_dot2c_f32_bf16 v17, v112, v44
    v_dot2c_f32_bf16 v18, v113, v60
    v_dot2c_f32_bf16 v19, v113, v44
    v_dot2c_f32_bf16 v20, v114, v60
    v_dot2c_f32_bf16 v21, v114, v44
    v_dot2c_f32_bf16 v22, v115, v60
    v_dot2c_f32_bf16 v23, v115, v44
    s_waitcnt vmcnt(0)
    v_dot2c_f32_bf16 v16, v116, v61
    v_dot2c_f32_bf16 v17, v116, v45
    v_dot2c_f32_bf16 v18, v117, v61
    v_dot2c_f32_bf16 v19, v117, v45
    v_dot2c_f32_bf16 v20, v118, v61
    v_dot2c_f32_bf16 v21, v118, v45
    v_dot2c_f32_bf16 v22, v119, v61
    v_dot2c_f32_bf16 v23, v119, v45
    v_add_u32 v7, 448, v7
    s_add_u32 s23, s23, 1
    s_cmp_lt_u32 s23, 4
    s_cbranch_scc1 L_ffn1
    v_permlane32_swap_b32 v16, v20
    v_permlane32_swap_b32 v17, v21
    v_permlane32_swap_b32 v18, v22
    v_permlane32_swap_b32 v19, v23
    v_add_f32 v16, v16, v20
    v_add_f32 v17, v17, v21
    v_add_f32 v18, v18, v22
    v_add_f32 v19, v19, v23
    s_nop 0
    v_permlane16_swap_b32 v16, v18
    v_permlane16_swap_b32 v17, v19
    v_add_f32 v16, v16, v18
    v_add_f32 v17, v17, v19
    s_nop 0
    v_add_f32_dpp v24, v16, v16 row_ror:8 row_mask:0xf bank_mask:0xf
    s_nop 1
    v_add_f32_dpp v24, v17, v17 row_ror:8 row_mask:0xf bank_mask:0xc
    v_cvt_pk_bf16_f32 v24, v24, v24
    v_and_b32 v24, 0xffff0000, v24
    v_mul_f32 v25, 0xbfb8aa3b, v24
    v_exp_f32 v25, v25
    s_nop 0
    v_add_f32 v25, 1.0, v25
    v_rcp_f32 v25, v25
    s_nop 0
    v_mul_f32 v24, v24, v25
    v_cvt_pk_bf16_f32 v24, v24, v24
    v_and_b32 v24, 0xffff0000, v24
    s_mul_i32 s22, s21, 57344
    s_mov_b32 s23, 0
    v_mov_b32 v16, 0
    v_mov_b32 v17, 0
    v_mov_b32 v18, 0
    v_mov_b32 v19, 0
    v_mov_b32 v20, 0
    v_mov_b32 v21, 0
    v_mov_b32 v22, 0
    v_mov_b32 v23, 0
L_ffn2:
    buffer_load_dwordx4 v[64:67], v26, s[36:39], s22 offen nt
    s_add_u32 s22, s22, 896
    buffer_load_dwordx4 v[68:71], v26, s[36:39], s22 offen nt
    s_add_u32 s22, s22, 896
    buffer_load_dwordx4 v[72:75], v26, s[36:39], s22 offen nt
    s_add_u32 s22, s22, 896
    buffer_load_dwordx4 v[76:79], v26, s[36:39], s22 offen nt
    s_add_u32 s22, s22, 896
    buffer_load_dwordx4 v[80:83], v26, s[36:39], s22 offen nt
    s_add_u32 s22, s22, 896
    buffer_load_dwordx4 v[84:87], v26, s[36:39], s22 offen nt
    s_add_u32 s22, s22, 896
    buffer_load_dwordx4 v[88:91], v26, s[36:39], s22 offen nt
    s_add_u32 s22, s22, 896
    buffer_load_dwordx4 v[92:95], v26, s[36:39], s22 offen nt
    s_add_u32 s22, s22, 896
    buffer_load_dwordx4 v[96:99], v26, s[36:39], s22 offen nt
    s_add_u32 s22, s22, 896
    buffer_load_dwordx4 v[100:103], v26, s[36:39], s22 offen nt
    s_add_u32 s22, s22, 896
    buffer_load_dwordx4 v[104:107], v26, s[36:39], s22 offen nt
    s_add_u32 s22, s22, 896
    buffer_load_dwordx4 v[108:111], v26, s[36:39], s22 offen nt
    s_add_u32 s22, s22, 896
    buffer_load_dwordx4 v[112:115], v26, s[36:39], s22 offen nt
    s_add_u32 s22, s22, 896
    buffer_load_dwordx4 v[116:119], v26, s[36:39], s22 offen nt
    s_add_u32 s22, s22, 896
    buffer_load_dwordx4 v[120:123], v26, s[36:39], s22 offen nt
    s_add_u32 s22, s22, 896
    buffer_load_dwordx4 v[124:127], v26, s[36:39], s22 offen nt
    s_add_u32 s22, s22, 896
    s_add_u32 s24, s23, 0
    v_readlane_b32 s48, v24, s24
    s_add_u32 s24, s23, 8
    v_readlane_b32 s49, v24, s24
    s_add_u32 s24, s23, 16
    v_readlane_b32 s50, v24, s24
    s_add_u32 s24, s23, 24
    v_readlane_b32 s51, v24, s24
    s_add_u32 s24, s23, 32
    v_readlane_b32 s52, v24, s24
    s_add_u32 s24, s23, 40
    v_readlane_b32 s53, v24, s24
    s_add_u32 s24, s23, 48
    v_readlane_b32 s54, v24, s24
    s_add_u32 s24, s23, 56
    v_readlane_b32 s55, v24, s24
    s_lshr_b32 s56, s48, 16
    s_lshr_b32 s57, s49, 16
    s_lshr_b32 s58, s50, 16
    s_lshr_b32 s59, s51, 16
    s_lshr_b32 s60, s52, 16
    s_lshr_b32 s61, s53, 16
    s_lshr_b32 s62, s54, 16
    s_lshr_b32 s63, s55, 16
    s_waitcnt vmcnt(8)
    v_dot2c_f32_bf16 v16, s56, v64
    v_dot2c_f32_bf16 v17, s48, v64
    v_dot2c_f32_bf16 v18, s56, v65
    v_dot2c_f32_bf16 v19, s48, v65
    v_dot2c_f32_bf16 v20, s56, v66
    v_dot2c_f32_bf16 v21, s48, v66
    v_dot2c_f32_bf16 v22, s56, v67
    v_dot2c_f32_bf16 v23, s48, v67
    v_dot2c_f32_bf16 v16, s57, v68
    v_dot2c_f32_bf16 v17, s49, v68
    v_dot2c_f32_bf16 v18, s57, v69
    v_dot2c_f32_bf16 v19, s49, v69
    v_dot2c_f32_bf16 v20, s57, v70
    v_dot2c_f32_bf16 v21, s49, v70
    v_dot2c_f32_bf16 v22, s57, v71
    v_dot2c_f32_bf16 v23, s49, v71
    v_dot2c_f32_bf16 v16, s58, v72
    v_dot2c_f32_bf16 v17, s50, v72
    v_dot2c_f32_bf16 v18, s58, v73
    v_dot2c_f32_bf16 v19, s50, v73
    v_dot2c_f32_bf16 v20, s58, v74
    v_dot2c_f32_bf16 v21, s50, v74
    v_dot2c_f32_bf16 v22, s58, v75
    v_dot2c_f32_bf16 v23, s50, v75
    v_dot2c_f32_bf16 v16, s59, v76
    v_dot2c_f32_bf16 v17, s51, v76
    v_dot2c_f32_bf16 v18, s59, v77
    v_dot2c_f32_bf16 v19, s51, v77
    v_dot2c_f32_bf16 v20, s59, v78
    v_dot2c_f32_bf16 v21, s51, v78
    v_dot2c_f32_bf16 v22, s59, v79
    v_dot2c_f32_bf16 v23, s51, v79
    v_dot2c_f32_bf16 v16, s60, v80
    v_dot2c_f32_bf16 v17, s52, v80
    v_dot2c_f32_bf16 v18, s60, v81
    v_dot2c_f32_bf16 v19, s52, v81
    v_dot2c_f32_bf16 v20, s60, v82
    v_dot2c_f32_bf16 v21, s52, v82
    v_dot2c_f32_bf16 v22, s60, v83
    v_dot2c_f32_bf16 v23, s52, v83
    v_dot2c_f32_bf16 v16, s61, v84
    v_dot2c_f32_bf16 v17, s53, v84
    v_dot2c_f32_bf16 v18, s61, v85
    v_dot2c_f32_bf16 v19, s53, v85
    v_dot2c_f32_bf16 v20, s61, v86
    v_dot2c_f32_bf16 v21, s53, v86
    v_dot2c_f32_bf16 v22, s61, v87
    v_dot2c_f32_bf16 v23, s53, v87
    v_dot2c_f32_bf16 v16, s62, v88
    v_dot2c_f32_bf16 v17, s54, v88
    v_dot2c_f32_bf16 v18, s62, v89
    v_dot2c_f32_bf16 v19, s54, v89
    v_dot2c_f32_bf16 v20, s62, v90
    v_dot2c_f32_bf16 v21, s54, v90
    v_dot2c_f32_bf16 v22, s62, v91
    v_dot2c_f32_bf16 v23, s54, v91
    v_dot2c_f32_bf16 v16, s63, v92
    v_dot2c_f32_bf16 v17, s55, v92
    v_dot2c_f32_bf16 v18, s63, v93
    v_dot2c_f32_bf16 v19, s55, v93
    v_dot2c_f32_bf16 v20, s63, v94
    v_dot2c_f32_bf16 v21, s55, v94
    v_dot2c_f32_bf16 v22, s63, v95
    v_dot2c_f32_bf16 v23, s55, v95
    s_add_u32 s24, s23, 1
    v_readlane_b32 s48, v24, s24
    s_add_u32 s24, s23, 9
    v_readlane_b32 s49, v24, s24
    s_add_u32 s24, s23, 17
    v_readlane_b32 s50, v24, s24
    s_add_u32 s24, s23, 25
    v_readlane_b32 s51, v24, s24
    s_add_u32 s24, s23, 33
    v_readlane_b32 s52, v24, s24
    s_add_u32 s24, s23, 41
    v_readlane_b32 s53, v24, s24
    s_add_u32 s24, s23, 49
    v_readlane_b32 s54, v24, s24
    s_add_u32 s24, s23, 57
    v_readlane_b32 s55, v24, s24
    s_lshr_b32 s56, s48, 16
    s_lshr_b32 s57, s49, 16
    s_lshr_b32 s58, s50, 16
    s_lshr_b32 s59, s51, 16
    s_lshr_b32 s60, s52, 16
    s_lshr_b32 s61, s53, 16
    s_lshr_b32 s62, s54, 16
    s_lshr_b32 s63, s55, 16
    s_waitcnt vmcnt(0)
    v_dot2c_f32_bf16 v16, s56, v96
    v_dot2c_f32_bf16 v17, s48, v96
    v_dot2c_f32_bf16 v18, s56, v97
    v_dot2c_f32_bf16 v19, s48, v97
    v_dot2c_f32_bf16 v20, s56, v98
    v_dot2c_f32_bf16 v21, s48, v98
    v_dot2c_f32_bf16 v22, s56, v99
    v_dot2c_f32_bf16 v23, s48, v99
    v_dot2c_f32_bf16 v16, s57, v100
    v_dot2c_f32_bf16 v17, s49, v100
    v_dot2c_f32_bf16 v18, s57, v101
    v_dot2c_f32_bf16 v19, s49, v101
    v_dot2c_f32_bf16 v20, s57, v102
    v_dot2c_f32_bf16 v21, s49, v102
    v_dot2c_f32_bf16 v22, s57, v103
    v_dot2c_f32_bf16 v23, s49, v103
    v_dot2c_f32_bf16 v16, s58, v104
    v_dot2c_f32_bf16 v17, s50, v104
    v_dot2c_f32_bf16 v18, s58, v105
    v_dot2c_f32_bf16 v19, s50, v105
    v_dot2c_f32_bf16 v20, s58, v106
    v_dot2c_f32_bf16 v21, s50, v106
    v_dot2c_f32_bf16 v22, s58, v107
    v_dot2c_f32_bf16 v23, s50, v107
    v_dot2c_f32_bf16 v16, s59, v108
    v_dot2c_f32_bf16 v17, s51, v108
    v_dot2c_f32_bf16 v18, s59, v109
    v_dot2c_f32_bf16 v19, s51, v109
    v_dot2c_f32_bf16 v20, s59, v110
    v_dot2c_f32_bf16 v21, s51, v110
    v_dot2c_f32_bf16 v22, s59, v111
    v_dot2c_f32_bf16 v23, s51, v111
    v_dot2c_f32_bf16 v16, s60, v112
    v_dot2c_f32_bf16 v17, s52, v112
    v_dot2c_f32_bf16 v18, s60, v113
    v_dot2c_f32_bf16 v19, s52, v113
    v_dot2c_f32_bf16 v20, s60, v114
    v_dot2c_f32_bf16 v21, s52, v114
    v_dot2c_f32_bf16 v22, s60, v115
    v_dot2c_f32_bf16 v23, s52, v115
    v_dot2c_f32_bf16 v16, s61, v116
    v_dot2c_f32_bf16 v17, s53, v116
    v_dot2c_f32_bf16 v18, s61, v117
    v_dot2c_f32_bf16 v19, s53, v117
    v_dot2c_f32_bf16 v20, s61, v118
    v_dot2c_f32_bf16 v21, s53, v118
    v_dot2c_f32_bf16 v22, s61, v119
    v_dot2c_f32_bf16 v23, s53, v119
    v_dot2c_f32_bf16 v16, s62, v120
    v_dot2c_f32_bf16 v17, s54, v120
    v_dot2c_f32_bf16 v18, s62, v121
    v_dot2c_f32_bf16 v19, s54, v121
    v_dot2c_f32_bf16 v20, s62, v122
    v_dot2c_f32_bf16 v21, s54, v122
    v_dot2c_f32_bf16 v22, s62, v123
    v_dot2c_f32_bf16 v23, s54, v123
    v_dot2c_f32_bf16 v16, s63, v124
    v_dot2c_f32_bf16 v17, s55, v124
    v_dot2c_f32_bf16 v18, s63, v125
    v_dot2c_f32_bf16 v19, s55, v125
    v_dot2c_f32_bf16 v20, s63, v126
    v_dot2c_f32_bf16 v21, s55, v126
    v_dot2c_f32_bf16 v22, s63, v127
    v_dot2c_f32_bf16 v23, s55, v127
    s_add_u32 s23, s23, 2
    s_cmp_lt_u32 s23, 8
    s_cbranch_scc1 L_ffn2
    s_lshl_b32 s24, s21, 11
    s_add_u32 s24, s24, 589824
    v_lshlrev_b32 v25, 1, v1
    buffer_store_dwordx4 v[16:19], v25, s[16:19], s24 offen sc1
    buffer_store_dwordx4 v[20:23], v25, s[16:19], s24 offen offset:16 sc1
L_noffn:
    s_waitcnt vmcnt(0)
    s_mov_b64 exec, 1
    v_mov_b32 v24, 1
    buffer_atomic_add v24, v5, s[44:47], 0 offen sc1
    s_mov_b64 exec, -1
    buffer_load_dwordx4 v[64:67], v26, s[12:15], s20 offen nt
    s_add_u32 s20, s20, 896
    buffer_load_dwordx4 v[68:71], v26, s[12:15], s20 offen nt
    s_add_u32 s20, s20, 896
    buffer_load_dwordx4 v[72:75], v26, s[12:15], s20 offen nt
    s_add_u32 s20, s20, 896
    buffer_load_dwordx4 v[76:79], v26, s[12:15], s20 offen nt
    s_add_u32 s20, s20, 896
    buffer_load_dwordx4 v[80:83], v26, s[12:15], s20 offen nt
    s_add_u32 s20, s20, 896
    buffer_load_dwordx4 v[84:87], v26, s[12:15], s20 offen nt
    s_add_u32 s20, s20, 896
    buffer_load_dwordx4 v[88:91], v26, s[12:15], s20 offen nt
    s_add_u32 s20, s20, 896
    buffer_load_dwordx4 v[92:95], v26, s[12:15], s20 offen nt
    s_add_u32 s20, s20, 896
    buffer_load_dwordx4 v[96:99], v26, s[12:15], s20 offen nt
    s_add_u32 s20, s20, 896
    buffer_load_dwordx4 v[100:103], v26, s[12:15], s20 offen nt
    s_add_u32 s20, s20, 896
    buffer_load_dwordx4 v[104:107], v26, s[12:15], s20 offen nt
    s_add_u32 s20, s20, 896
    buffer_load_dwordx4 v[108:111], v26, s[12:15], s20 offen nt
    s_add_u32 s20, s20, 896
    buffer_load_dwordx4 v[112:115], v26, s[12:15], s20 offen nt
    s_add_u32 s20, s20, 896
    buffer_load_dwordx4 v[116:119], v26, s[12:15], s20 offen nt
    s_add_u32 s20, s20, 896
    buffer_load_dwordx4 v[120:123], v26, s[12:15], s20 offen nt
    s_add_u32 s20, s20, 896
    buffer_load_dwordx4 v[124:127], v26, s[12:15], s20 offen nt
    s_add_u32 s20, s20, 896
    s_mov_b32 s24, 0x05040100
    s_mov_b32 s25, 0x07060302
    s_waitcnt vmcnt(0)
    v_perm_b32 v16, v68, v64, s24
    v_perm_b32 v68, v68, v64, s25
    v_mov_b32 v64, v16
    v_perm_b32 v16, v69, v65, s24
    v_perm_b32 v69, v69, v65, s25
    v_mov_b32 v65, v16
    v_perm_b32 v16, v70, v66, s24
    v_perm_b32 v70, v70, v66, s25
    v_mov_b32 v66, v16
    v_perm_b32 v16, v71, v67, s24
    v_perm_b32 v71, v71, v67, s25
    v_mov_b32 v67, v16
    v_perm_b32 v16, v76, v72, s24
    v_perm_b32 v76, v76, v72, s25
    v_mov_b32 v72, v16
    v_perm_b32 v16, v77, v73, s24
    v_perm_b32 v77, v77, v73, s25
    v_mov_b32 v73, v16
    v_perm_b32 v16, v78, v74, s24
    v_perm_b32 v78, v78, v74, s25
    v_mov_b32 v74, v16
    v_perm_b32 v16, v79, v75, s24
    v_perm_b32 v79, v79, v75, s25
    v_mov_b32 v75, v16
    v_perm_b32 v16, v84, v80, s24
    v_perm_b32 v84, v84, v80, s25
    v_mov_b32 v80, v16
    v_perm_b32 v16, v85, v81, s24
    v_perm_b32 v85, v85, v81, s25
    v_mov_b32 v81, v16
    v_perm_b32 v16, v86, v82, s24
    v_perm_b32 v86, v86, v82, s25
    v_mov_b32 v82, v16
    v_perm_b32 v16, v87, v83, s24
    v_perm_b32 v87, v87, v83, s25
    v_mov_b32 v83, v16
    v_perm_b32 v16, v92, v88, s24
    v_perm_b32 v92, v92, v88, s25
    v_mov_b32 v88, v16
    v_perm_b32 v16, v93, v89, s24
    v_perm_b32 v93, v93, v89, s25
    v_mov_b32 v89, v16
    v_perm_b32 v16, v94, v90, s24
    v_perm_b32 v94, v94, v90, s25
    v_mov_b32 v90, v16
    v_perm_b32 v16, v95, v91, s24
    v_perm_b32 v95, v95, v91, s25
    v_mov_b32 v91, v16
    v_perm_b32 v16, v100, v96, s24
    v_perm_b32 v100, v100, v96, s25
    v_mov_b32 v96, v16
    v_perm_b32 v16, v101, v97, s24
    v_perm_b32 v101, v101, v97, s25
    v_mov_b32 v97, v16
    v_perm_b32 v16, v102, v98, s24
    v_perm_b32 v102, v102, v98, s25
    v_mov_b32 v98, v16
    v_perm_b32 v16, v103, v99, s24
    v_perm_b32 v103, v103, v99, s25
    v_mov_b32 v99, v16
    v_perm_b32 v16, v108, v104, s24
    v_perm_b32 v108, v108, v104, s25
    v_mov_b32 v104, v16
    v_perm_b32 v16, v109, v105, s24
    v_perm_b32 v109, v109, v105, s25
    v_mov_b32 v105, v16
    v_perm_b32 v16, v110, v106, s24
    v_perm_b32 v110, v110, v106, s25
    v_mov_b32 v106, v16
    v_perm_b32 v16, v111, v107, s24
    v_perm_b32 v111, v111, v107, s25
    v_mov_b32 v107, v16
    v_perm_b32 v16, v116, v112, s24
    v_perm_b32 v116, v116, v112, s25
    v_mov_b32 v112, v16
    v_perm_b32 v16, v117, v113, s24
    v_perm_b32 v117, v117, v113, s25
    v_mov_b32 v113, v16
    v_perm_b32 v16, v118, v114, s24
    v_perm_b32 v118, v118, v114, s25
    v_mov_b32 v114, v16
    v_perm_b32 v16, v119, v115, s24
    v_perm_b32 v119, v119, v115, s25
    v_mov_b32 v115, v16
    v_perm_b32 v16, v124, v120, s24
    v_perm_b32 v124, v124, v120, s25
    v_mov_b32 v120, v16
    v_perm_b32 v16, v125, v121, s24
    v_perm_b32 v125, v125, v121, s25
    v_mov_b32 v121, v16
    v_perm_b32 v16, v126, v122, s24
    v_perm_b32 v126, v126, v122, s25
    v_mov_b32 v122, v16
    v_perm_b32 v16, v127, v123, s24
    v_perm_b32 v127, v127, v123, s25
    v_mov_b32 v123, v16
    v_lshrrev_b32 v62, 4, v0
    v_lshlrev_b32 v62, 1, v62
    s_lshl_b32 s21, s2, 3
    v_add_u32 v62, s21, v62
    s_mov_b32 s40, s80
    s_mov_b32 s41, s81
    s_mov_b32 s42, 896
    s_mov_b32 s43, 0x20000
    s_mov_b32 s24, 0x40000
L_prg:
    ds_read_b32 v16, v5 offset:2560
    s_waitcnt lgkmcnt(0)
    v_readfirstlane_b32 s25, v16
    s_nop 0
    s_cmp_ge_u32 s25, 160
    s_cbranch_scc1 L_rdy0
    s_sleep 64
    s_sub_u32 s24, s24, 1
    s_cmp_lg_u32 s24, 0
    s_cbranch_scc1 L_prg
L_rdy0:
    s_mov_b32 s24, 0x40000
L_rdy:
    buffer_load_dword v16, v5, s[44:47], 0 offen sc1
    s_waitcnt vmcnt(0)
    v_readfirstlane_b32 s25, v16
    s_nop 0
    s_cmp_ge_u32 s25, 256
    s_cbranch_scc1 L_rdyok
    s_sleep 127
    s_sub_u32 s24, s24, 1
    s_cmp_lg_u32 s24, 0
    s_cbranch_scc1 L_rdy
L_rdyok:
    s_mov_b64 exec, 1
    s_cmp_eq_u32 s2, 0
    s_cselect_b32 s24, 0, 2130706432
    v_mov_b32 v18, s30
    v_mov_b32 v19, s31
    buffer_store_dwordx2 v[18:19], v5, s[16:19], s24 offen sc1
    s_mov_b64 exec, -1
    s_cmp_ge_u32 s2, 112
    s_cbranch_scc1 L_nog
    v_lshlrev_b32 v16, 11, v0
    v_mov_b32 v17, 2130706432
    v_cmp_gt_u32 vcc, 28, v0
    s_nop 1
    v_cndmask_b32 v17, v17, v16, vcc
    s_lshl_b32 s20, s2, 4
    s_add_u32 s20, s20, 589824
    buffer_load_dwordx4 v[20:23], v17, s[16:19], s20 offen sc1
    s_mov_b32 s8, s64
    s_mov_b32 s9, s65
    s_mov_b32 s10, 896
    s_mov_b32 s11, 0x20000
    buffer_load_ushort v61, v62, s[8:11], 0 offen
    s_waitcnt vmcnt(0)
    v_permlane32_swap_b32 v20, v22
    v_permlane32_swap_b32 v21, v23
    v_add_f32 v20, v20, v22
    v_add_f32 v21, v21, v23
    s_nop 1
    v_permlane16_swap_b32 v20, v21
    v_add_f32 v20, v20, v21
    s_nop 1
    v_add_f32_dpp v20, v20, v20 quad_perm:[1,0,3,2] row_mask:0xf bank_mask:0xf
    s_nop 1
    v_add_f32_dpp v20, v20, v20 quad_perm:[2,3,0,1] row_mask:0xf bank_mask:0xf
    s_nop 1
    v_add_f32_dpp v20, v20, v20 row_half_mirror row_mask:0xf bank_mask:0xf
    s_nop 1
    v_add_f32_dpp v20, v20, v20 row_mirror row_mask:0xf bank_mask:0xf
    v_cvt_pk_bf16_f32 v20, v20, v20
    v_and_b32 v20, 0xffff0000, v20
    v_mul_f32 v21, 0xbfb8aa3b, v20
    v_exp_f32 v21, v21
    s_nop 0
    v_add_f32 v21, 1.0, v21
    v_rcp_f32 v21, v21
    s_nop 0
    v_mul_f32 v60, v20, v21
    v_cvt_pk_bf16_f32 v60, v60, v60
    v_and_b32 v60, 0xffff0000, v60
    v_lshlrev_b32 v61, 16, v61
L_nog:
    v_and_b32 v63, 31, v0
    v_lshlrev_b32 v63, 5, v63
    v_lshrrev_b32 v17, 5, v0
    v_lshl_add_u32 v63, v17, 4, v63
    v_mov_b32 v58, 2130706432
    v_and_b32 v16, 15, v0
    v_lshlrev_b32 v56, 6, v16
    v_lshrrev_b32 v17, 4, v0
    v_lshl_add_u32 v56, v17, 4, v56
    v_lshlrev_b32 v57, 3, v16
    s_mov_b32 s20, s34
    s_mov_b32 s21, s35
    v_lshrrev_b32 v17, 6, v63
    v_and_b32 v31, 63, v63
    v_lshl_add_u32 v31, v17, 10, v31
    s_lshl_b32 s34, s4, 14
    s_lshl_b32 s24, s5, 6
    s_add_u32 s34, s34, s24
    s_add_u32 s34, s34, 262144
    s_lshl_b32 s35, s4, 11
    s_lshl_b32 s24, s5, 3
    s_add_u32 s35, s35, s24
    s_add_u32 s35, s35, 524288
    v_lshlrev_b32 v17, 7, v0
    v_cmp_gt_u32 vcc, 16, v0
    s_nop 1
    v_cndmask_b32 v15, v58, v17, vcc
    v_lshlrev_b32 v17, 13, v0
    v_cmp_gt_u32 vcc, 56, v0
    s_nop 1
    v_cndmask_b32 v58, v58, v17, vcc
    s_lshl_b32 s22, s2, 4
    s_add_u32 s22, s22, 1048576
    s_add_u32 s23, s22, 4096
    v_lshlrev_b32 v59, 4, v0
    s_lshl_b32 s26, s2, 12
    s_add_u32 s26, s26, 1048576
    s_mov_b32 s54, 0x00010001
    s_mov_b32 s55, 0x00010001
    s_waitcnt vmcnt(0) lgkmcnt(0)
    s_mov_b32 s48, 0
    s_mov_b64 exec, 0
    s_branch L_sfin
L_again:
    s_mov_b32 s48, 1
    s_mov_b64 exec, -1
    s_setprio 2
    s_mov_b32 s36, 0
    s_mov_b32 s37, 0
    s_mov_b32 s49, 0x400000
    s_mov_b32 s31, 0
    s_mov_b32 s58, 4096
    s_mov_b32 s56, 252
    s_mov_b32 s57, 7
    s_mul_i32 s59, s4, 0
    s_add_u32 s60, s84, s33
    s_addc_u32 s61, s85, 0
L_dyn:
    s_sub_u32 s49, s49, 1
    s_cmp_eq_u32 s49, 0
    s_cbranch_scc1 L_dend
    ds_read_b32 v16, v5 offset:2560
    s_waitcnt lgkmcnt(0)
    v_readfirstlane_b32 s24, v16
    s_nop 0
    s_sub_u32 s24, s24, s36
    s_sub_u32 s24, s24, s56
    s_cmp_ge_i32 s24, 1
    s_cbranch_scc1 L_req
    s_sleep 4
    s_branch L_dyn
L_req:
    s_min_i32 s24, s24, 32
    s_lshr_b32 s50, s24, s57
    s_max_u32 s50, s50, 1
    s_add_u32 s31, s31, 1
    s_mov_b32 s52, s50
    s_atomic_add s52, s[60:61], 0 glc
    s_waitcnt lgkmcnt(0)
    s_add_u32 s37, s52, s50
    s_min_u32 s24, s52, 144
    s_lshr_b32 s25, s24, 4
    s_min_u32 s25, s25, 8
    s_lshl_b32 s53, s25, 4
    s_sub_u32 s24, s24, s53
    s_lshr_b32 s53, 128, s25
    s_max_u32 s53, s53, 1
    s_mul_i32 s24, s24, s53
    s_lshr_b32 s53, s58, s25
    s_sub_u32 s24, s24, s53
    s_add_u32 s53, s24, s58
    s_min_u32 s24, s37, 144
    s_lshr_b32 s25, s24, 4
    s_min_u32 s25, s25, 8
    s_lshl_b32 s51, s25, 4
    s_sub_u32 s24, s24, s51
    s_lshr_b32 s51, 128, s25
    s_max_u32 s51, s51, 1
    s_mul_i32 s24, s24, s51
    s_lshr_b32 s51, s58, s25
    s_sub_u32 s24, s24, s51
    s_add_u32 s51, s24, s58
    s_sub_u32 s57, 7, s25
    s_max_i32 s57, s57, 0
    s_cmp_le_u32 s57, 4
    s_cselect_b32 s56, 4, 0
    s_add_u32 s56, s56, 252
    v_add_u32 v16, s53, v0
    v_cmp_gt_u32 vcc, s51, v16
    v_lshrrev_b32 v17, 8, v16
    v_and_b32 v16, 255, v16
    v_add_u32 v16, 256, v16
    v_bfe_u32 v18, v16, 0, 1
    v_lshlrev_b32 v18, 3, v18
    v_xor_b32 v16, v16, v18
    v_bfe_u32 v18, v16, 3, 1
    v_lshlrev_b32 v18, 0, v18
    v_xor_b32 v16, v16, v18
    v_bfe_u32 v18, v16, 0, 1
    v_lshlrev_b32 v18, 3, v18
    v_xor_b32 v16, v16, v18
    v_bfe_u32 v18, v16, 4, 1
    v_lshlrev_b32 v18, 6, v18
    v_xor_b32 v16, v16, v18
    v_bfe_u32 v18, v16, 6, 1
    v_lshlrev_b32 v18, 4, v18
    v_xor_b32 v16, v16, v18
    v_bfe_u32 v18, v16, 4, 1
    v_lshlrev_b32 v18, 6, v18
    v_xor_b32 v16, v16, v18
    v_and_b32 v18, 15, v16
    v_lshrrev_b32 v16, 4, v16
    v_lshl_or_b32 v16, v16, 5, v18
    v_and_b32 v18, 63, v16
    v_lshrrev_b32 v16, 6, v16
    v_lshl_or_b32 v16, v16, 7, v18
    v_and_b32 v18, 127, v16
    v_lshrrev_b32 v16, 7, v16
    v_lshl_or_b32 v16, v16, 8, v18
    v_lshl_add_u32 v16, v17, 12, v16
    v_lshlrev_b32 v16, 9, v16
    v_add_u32 v17, s36, v0
    v_lshlrev_b32 v17, 2, v17
    s_mov_b64 exec, vcc
    ds_write_b32 v17, v16 offset:9216
    s_mov_b64 exec, -1
    v_add_u32 v16, s53, v0
    v_add_u32 v16, 64, v16
    v_cmp_gt_u32 vcc, s51, v16
    v_lshrrev_b32 v17, 8, v16
    v_and_b32 v16, 255, v16
    v_add_u32 v16, 256, v16
    v_bfe_u32 v18, v16, 0, 1
    v_lshlrev_b32 v18, 3, v18
    v_xor_b32 v16, v16, v18
    v_bfe_u32 v18, v16, 3, 1
    v_lshlrev_b32 v18, 0, v18
    v_xor_b32 v16, v16, v18
    v_bfe_u32 v18, v16, 0, 1
    v_lshlrev_b32 v18, 3, v18
    v_xor_b32 v16, v16, v18
    v_bfe_u32 v18, v16, 4, 1
    v_lshlrev_b32 v18, 6, v18
    v_xor_b32 v16, v16, v18
    v_bfe_u32 v18, v16, 6, 1
    v_lshlrev_b32 v18, 4, v18
    v_xor_b32 v16, v16, v18
    v_bfe_u32 v18, v16, 4, 1
    v_lshlrev_b32 v18, 6, v18
    v_xor_b32 v16, v16, v18
    v_and_b32 v18, 15, v16
    v_lshrrev_b32 v16, 4, v16
    v_lshl_or_b32 v16, v16, 5, v18
    v_and_b32 v18, 63, v16
    v_lshrrev_b32 v16, 6, v16
    v_lshl_or_b32 v16, v16, 7, v18
    v_and_b32 v18, 127, v16
    v_lshrrev_b32 v16, 7, v16
    v_lshl_or_b32 v16, v16, 8, v18
    v_lshl_add_u32 v16, v17, 12, v16
    v_lshlrev_b32 v16, 9, v16
    v_add_u32 v17, s36, v0
    v_lshlrev_b32 v17, 2, v17
    s_mov_b64 exec, vcc
    ds_write_b32 v17, v16 offset:9472
    s_mov_b64 exec, -1
    s_sub_u32 s24, s51, s53
    s_add_u32 s36, s36, s24
    s_cmp_lt_u32 s51, s58
    s_cbranch_scc1 L_dyn
L_dend:
    v_add_u32 v17, s36, v0
    v_lshlrev_b32 v17, 2, v17
    v_mov_b32 v16, 2130706432
    ds_write_b32 v17, v16 offset:9216
    s_waitcnt lgkmcnt(0)
    s_setprio 3
    s_barrier
L_htail:
    ds_read_b128 v[48:51], v5 offset:2624
    ds_read_b128 v[52:55], v5 offset:2640
    ds_read_b128 v[32:35], v63 offset:4096
    ds_read_b128 v[36:39], v63 offset:5120
    ds_read_b128 v[40:43], v63 offset:6144
    ds_read_b128 v[44:47], v63 offset:7168
    s_mov_b32 s24, 0x40000
    s_waitcnt lgkmcnt(4)
    v_max3_f32 v12, v48, v50, v52
    v_max_f32 v12, v12, v54
    v_sub_f32 v48, v48, v12
    v_sub_f32 v50, v50, v12
    v_sub_f32 v52, v52, v12
    v_sub_f32 v54, v54, v12
    v_exp_f32 v48, v48
    v_exp_f32 v50, v50
    v_exp_f32 v52, v52
    v_exp_f32 v54, v54
    v_min_u32 v12, -2, v12
    v_mul_f32 v13, v48, v49
    s_waitcnt lgkmcnt(0)
    v_mul_f32 v8, v48, v32
    v_mul_f32 v9, v48, v33
    v_mul_f32 v10, v48, v34
    v_mul_f32 v11, v48, v35
    v_fmac_f32 v13, v50, v51
    v_fmac_f32 v8, v50, v36
    v_fmac_f32 v9, v50, v37
    v_fmac_f32 v10, v50, v38
    v_fmac_f32 v11, v50, v39
    v_fmac_f32 v13, v52, v53
    v_fmac_f32 v8, v52, v40
    v_fmac_f32 v9, v52, v41
    v_fmac_f32 v10, v52, v42
    v_fmac_f32 v11, v52, v43
    v_fmac_f32 v13, v54, v55
    v_fmac_f32 v8, v54, v44
    v_fmac_f32 v9, v54, v45
    v_fmac_f32 v10, v54, v46
    v_fmac_f32 v11, v54, v47
    v_min_u32 v8, -2, v8
    v_min_u32 v9, -2, v9
    v_min_u32 v10, -2, v10
    v_min_u32 v11, -2, v11
    v_min_u32 v13, -2, v13
    buffer_store_dwordx4 v[8:11], v31, s[16:19], s34 offen sc1
    buffer_store_dwordx2 v[12:13], v15, s[16:19], s35 offen sc1
    s_waitcnt vmcnt(0)
L_h1:
    buffer_load_dwordx2 v[48:49], v57, s[16:19], s21 offen sc1
    buffer_load_dwordx4 v[32:35], v56, s[16:19], s20 offen sc1
    s_waitcnt vmcnt(0)
    v_max3_u32 v16, v32, v33, v34
    v_max3_u32 v17, v35, v48, v49
    v_max_u32 v16, v16, v17
    v_cmp_eq_u32 vcc, -1, v16
    s_cbranch_vccz L_h1ok
    s_sub_u32 s24, s24, 1
    s_cmp_lg_u32 s24, 0
    s_cbranch_scc1 L_h1
L_h1ok:
    v_max_f32_dpp v14, v48, v48 quad_perm:[1,0,3,2] row_mask:0xf bank_mask:0xf
    s_nop 1
    v_max_f32_dpp v14, v14, v14 quad_perm:[2,3,0,1] row_mask:0xf bank_mask:0xf
    s_nop 1
    v_max_f32_dpp v14, v14, v14 row_half_mirror row_mask:0xf bank_mask:0xf
    s_nop 1
    v_max_f32_dpp v14, v14, v14 row_mirror row_mask:0xf bank_mask:0xf
    v_sub_f32 v14, v48, v14
    v_exp_f32 v14, v14
    s_nop 0
    v_mul_f32 v20, v14, v49
    v_mul_f32 v16, v14, v32
    v_mul_f32 v17, v14, v33
    v_mul_f32 v18, v14, v34
    v_mul_f32 v19, v14, v35
    v_add_f32_dpp v20, v20, v20 quad_perm:[1,0,3,2] row_mask:0xf bank_mask:0xf
    v_add_f32_dpp v16, v16, v16 quad_perm:[1,0,3,2] row_mask:0xf bank_mask:0xf
    v_add_f32_dpp v17, v17, v17 quad_perm:[1,0,3,2] row_mask:0xf bank_mask:0xf
    v_add_f32_dpp v18, v18, v18 quad_perm:[1,0,3,2] row_mask:0xf bank_mask:0xf
    v_add_f32_dpp v19, v19, v19 quad_perm:[1,0,3,2] row_mask:0xf bank_mask:0xf
    v_add_f32_dpp v20, v20, v20 quad_perm:[2,3,0,1] row_mask:0xf bank_mask:0xf
    v_add_f32_dpp v16, v16, v16 quad_perm:[2,3,0,1] row_mask:0xf bank_mask:0xf
    v_add_f32_dpp v17, v17, v17 quad_perm:[2,3,0,1] row_mask:0xf bank_mask:0xf
    v_add_f32_dpp v18, v18, v18 quad_perm:[2,3,0,1] row_mask:0xf bank_mask:0xf
    v_add_f32_dpp v19, v19, v19 quad_perm:[2,3,0,1] row_mask:0xf bank_mask:0xf
    v_add_f32_dpp v20, v20, v20 row_half_mirror row_mask:0xf bank_mask:0xf
    v_add_f32_dpp v16, v16, v16 row_half_mirror row_mask:0xf bank_mask:0xf
    v_add_f32_dpp v17, v17, v17 row_half_mirror row_mask:0xf bank_mask:0xf
    v_add_f32_dpp v18, v18, v18 row_half_mirror row_mask:0xf bank_mask:0xf
    v_add_f32_dpp v19, v19, v19 row_half_mirror row_mask:0xf bank_mask:0xf
    v_add_f32_dpp v20, v20, v20 row_mirror row_mask:0xf bank_mask:0xf
    v_add_f32_dpp v16, v16, v16 row_mirror row_mask:0xf bank_mask:0xf
    v_add_f32_dpp v17, v17, v17 row_mirror row_mask:0xf bank_mask:0xf
    v_add_f32_dpp v18, v18, v18 row_mirror row_mask:0xf bank_mask:0xf
    v_add_f32_dpp v19, v19, v19 row_mirror row_mask:0xf bank_mask:0xf
    v_rcp_f32 v21, v20
    s_nop 0
    v_mul_f32 v22, v16, v21
    v_mul_f32 v23, v17, v21
    v_mul_f32 v24, v18, v21
    v_mul_f32 v25, v19, v21
    v_fma_f32 v16, -v22, v20, v16
    v_fma_f32 v17, -v23, v20, v17
    v_fma_f32 v18, -v24, v20, v18
    v_fma_f32 v19, -v25, v20, v19
    v_fma_f32 v16, v16, v21, v22
    v_fma_f32 v17, v17, v21, v23
    v_fma_f32 v18, v18, v21, v24
    v_fma_f32 v19, v19, v21, v25
    v_cvt_pk_bf16_f32 v16, v16, v17
    v_cvt_pk_bf16_f32 v18, v18, v19
    v_readlane_b32 s56, v16, 0
    v_readlane_b32 s57, v18, 0
    v_readlane_b32 s58, v16, 16
    v_readlane_b32 s59, v18, 16
    v_readlane_b32 s60, v16, 32
    v_readlane_b32 s61, v18, 32
    v_readlane_b32 s62, v16, 48
    v_readlane_b32 s63, v18, 48
    v_dot2_f32_bf16 v16, v64, s56, 0
    v_dot2_f32_bf16 v17, v68, s56, 0
    v_dot2_f32_bf16 v18, v65, s56, 0
    v_dot2_f32_bf16 v19, v69, s56, 0
    v_dot2_f32_bf16 v20, v66, s56, 0
    v_dot2_f32_bf16 v21, v70, s56, 0
    v_dot2_f32_bf16 v22, v67, s56, 0
    v_dot2_f32_bf16 v23, v71, s56, 0
    v_dot2_f32_bf16 v16, v72, s57, v16
    v_dot2_f32_bf16 v17, v76, s57, v17
    v_dot2_f32_bf16 v18, v73, s57, v18
    v_dot2_f32_bf16 v19, v77, s57, v19
    v_dot2_f32_bf16 v20, v74, s57, v20
    v_dot2_f32_bf16 v21, v78, s57, v21
    v_dot2_f32_bf16 v22, v75, s57, v22
    v_dot2_f32_bf16 v23, v79, s57, v23
    v_dot2_f32_bf16 v16, v80, s58, v16
    v_dot2_f32_bf16 v17, v84, s58, v17
    v_dot2_f32_bf16 v18, v81, s58, v18
    v_dot2_f32_bf16 v19, v85, s58, v19
    v_dot2_f32_bf16 v20, v82, s58, v20
    v_dot2_f32_bf16 v21, v86, s58, v21
    v_dot2_f32_bf16 v22, v83, s58, v22
    v_dot2_f32_bf16 v23, v87, s58, v23
    v_dot2_f32_bf16 v16, v88, s59, v16
    v_dot2_f32_bf16 v17, v92, s59, v17
    v_dot2_f32_bf16 v18, v89, s59, v18
    v_dot2_f32_bf16 v19, v93, s59, v19
    v_dot2_f32_bf16 v20, v90, s59, v20
    v_dot2_f32_bf16 v21, v94, s59, v21
    v_dot2_f32_bf16 v22, v91, s59, v22
    v_dot2_f32_bf16 v23, v95, s59, v23
    v_dot2_f32_bf16 v16, v96, s60, v16
    v_dot2_f32_bf16 v17, v100, s60, v17
    v_dot2_f32_bf16 v18, v97, s60, v18
    v_dot2_f32_bf16 v19, v101, s60, v19
    v_dot2_f32_bf16 v20, v98, s60, v20
    v_dot2_f32_bf16 v21, v102, s60, v21
    v_dot2_f32_bf16 v22, v99, s60, v22
    v_dot2_f32_bf16 v23, v103, s60, v23
    v_dot2_f32_bf16 v16, v104, s61, v16
    v_dot2_f32_bf16 v17, v108, s61, v17
    v_dot2_f32_bf16 v18, v105, s61, v18
    v_dot2_f32_bf16 v19, v109, s61, v19
    v_dot2_f32_bf16 v20, v106, s61, v20
    v_dot2_f32_bf16 v21, v110, s61, v21
    v_dot2_f32_bf16 v22, v107, s61, v22
    v_dot2_f32_bf16 v23, v111, s61, v23
    v_dot2_f32_bf16 v16, v112, s62, v16
    v_dot2_f32_bf16 v17, v116, s62, v17
    v_dot2_f32_bf16 v18, v113, s62, v18
    v_dot2_f32_bf16 v19, v117, s62, v19
    v_dot2_f32_bf16 v20, v114, s62, v20
    v_dot2_f32_bf16 v21, v118, s62, v21
    v_dot2_f32_bf16 v22, v115, s62, v22
    v_dot2_f32_bf16 v23, v119, s62, v23
    v_dot2_f32_bf16 v16, v120, s63, v16
    v_dot2_f32_bf16 v17, v124, s63, v17
    v_dot2_f32_bf16 v18, v121, s63, v18
    v_dot2_f32_bf16 v19, v125, s63, v19
    v_dot2_f32_bf16 v20, v122, s63, v20
    v_dot2_f32_bf16 v21, v126, s63, v21
    v_dot2_f32_bf16 v22, v123, s63, v22
    v_dot2_f32_bf16 v23, v127, s63, v23
    v_min_u32 v16, -2, v16
    v_min_u32 v17, -2, v17
    v_min_u32 v18, -2, v18
    v_min_u32 v19, -2, v19
    v_min_u32 v20, -2, v20
    v_min_u32 v21, -2, v21
    v_min_u32 v22, -2, v22
    v_min_u32 v23, -2, v23
    buffer_store_dwordx4 v[16:19], v58, s[16:19], s22 offen sc1
    buffer_store_dwordx4 v[20:23], v58, s[16:19], s23 offen sc1
    s_cmp_ge_u32 s2, 112
    s_cbranch_scc1 L_hend
    s_mov_b32 s24, 0x40000
    s_waitcnt vmcnt(0)
L_h2:
    buffer_load_dwordx4 v[128:131], v59, s[16:19], s26 offen offset:0 sc1
    buffer_load_dwordx4 v[132:135], v59, s[16:19], s26 offen offset:1024 sc1
    buffer_load_dwordx4 v[136:139], v59, s[16:19], s26 offen offset:2048 sc1
    buffer_load_dwordx4 v[140:143], v59, s[16:19], s26 offen offset:3072 sc1
    s_waitcnt vmcnt(0)
    v_max3_u32 v16, v128, v129, v130
    v_max3_u32 v17, v131, v132, v133
    v_max3_u32 v18, v134, v135, v136
    v_max3_u32 v19, v137, v138, v139
    v_max3_u32 v16, v16, v140, v141
    v_max3_u32 v17, v17, v142, v143
    v_max3_u32 v16, v16, v18, v19
    v_max_u32 v16, v16, v17
    v_cmp_eq_u32 vcc, -1, v16
    s_cbranch_vccz L_h2ok
    s_sub_u32 s24, s24, 1
    s_cmp_lg_u32 s24, 0
    s_cbranch_scc1 L_h2
L_h2ok:
    v_add_f32 v20, v128, v132
    v_add_f32 v24, v136, v140
    v_add_f32 v21, v129, v133
    v_add_f32 v25, v137, v141
    v_add_f32 v22, v130, v134
    v_add_f32 v26, v138, v142
    v_add_f32 v23, v131, v135
    v_add_f32 v27, v139, v143
    v_add_f32 v20, v20, v24
    v_add_f32 v21, v21, v25
    v_add_f32 v22, v22, v26
    v_add_f32 v23, v23, v27
    s_nop 0
    v_permlane32_swap_b32 v20, v22
    v_permlane32_swap_b32 v21, v23
    v_add_f32 v20, v20, v22
    v_add_f32 v21, v21, v23
    s_nop 1
    v_permlane16_swap_b32 v20, v21
    v_add_f32 v20, v20, v21
    s_nop 1
    v_add_f32_dpp v20, v20, v20 quad_perm:[1,0,3,2] row_mask:0xf bank_mask:0xf
    s_nop 1
    v_add_f32_dpp v20, v20, v20 quad_perm:[2,3,0,1] row_mask:0xf bank_mask:0xf
    s_nop 1
    v_add_f32_dpp v20, v20, v20 row_half_mirror row_mask:0xf bank_mask:0xf
    s_nop 1
    v_add_f32_dpp v20, v20, v20 row_mirror row_mask:0xf bank_mask:0xf
    v_cvt_pk_bf16_f32 v20, v20, v20
    v_and_b32 v20, 0xffff0000, v20
    v_mul_f32 v20, v20, v60
    v_cvt_pk_bf16_f32 v20, v20, v20
    v_and_b32 v20, 0xffff0000, v20
    v_add_f32 v20, v61, v20
    v_cvt_pk_bf16_f32 v20, v20, v20
    s_and_b64 exec, exec, s[54:55]
    buffer_store_short v20, v62, s[40:43], 0 offen
L_hend:
    s_cmp_eq_u32 s48, 0
    s_cbranch_scc1 L_again
L_end:
    s_endpgm
.section .rodata,"a"
.p2align 6
.amdhsa_kernel recurrent_scan__mha_block_cached__dense_activation_silu__decode_kernel
  .amdhsa_next_free_vgpr 172
  .amdhsa_next_free_sgpr 98
  .amdhsa_accum_offset 172
  .amdhsa_group_segment_fixed_size 0
  .amdhsa_kernarg_size 88
  .amdhsa_user_sgpr_count 2
  .amdhsa_user_sgpr_kernarg_segment_ptr 1
  .amdhsa_system_sgpr_workgroup_id_x 1
.end_amdhsa_kernel
```
